```python
import torch

def _softmax(x, axis=-1):
    return torch.softmax(x, dim=axis)
def _gelu(x):
    return torch.nn.functional.gelu(x, approximate="tanh")
def _silu(x):
    return torch.nn.functional.silu(x)
def _sigmoid(x):
    return torch.sigmoid(x)
def _layernorm(x, axis=-1, eps=1e-5):
    m = x.mean(dim=axis, keepdim=True)
    v = x.var(dim=axis, keepdim=True, unbiased=False)
    return (x - m) / torch.sqrt(v + eps)
def _scatter_add(tgt, idx, src, axis=0):
    return tgt.clone().index_add_(axis, idx, src)
def _segment_sum(src, seg, n):
    out = torch.zeros((n,) + src.shape[1:], dtype=src.dtype)
    return out.index_add_(0, seg, src)
def _pad(x, pw):
    flat = tuple(v for pair in reversed(pw) for v in pair)
    return torch.nn.functional.pad(x, flat)

kernel_name = 'gather_scatter__edge_featured_mpnn_gatedgcn__graph'

def setup_inputs():

    _w = (lambda a: (lambda t: t.to(torch.bfloat16) if t.is_floating_point() else t)(torch.as_tensor(a)))
    N, deg, D, De = 50000, 16, 64, max(4, 1)
    E = N * deg
    return {
        "x": _w((lambda *s: torch.randn(*s, dtype=torch.bfloat16) * 0.4)(N, D)),
        "e_attr": _w((lambda *s: torch.randn(*s, dtype=torch.bfloat16) * 0.8)(E, De)),
        "src": _w((lambda lo, hi, *s: torch.randint(lo, hi, s))(0, N, E).to(torch.int64)),
        "dst": _w((lambda lo, hi, *s: torch.randint(lo, hi, s))(0, N, E).to(torch.int64)),
        "w_a": _w((lambda *s: torch.randn(*s, dtype=torch.bfloat16) * 0.8)(D, D)),
        "w_b": _w((lambda *s: torch.randn(*s, dtype=torch.bfloat16) * 0.4)(D, D)),
        "w_c": _w((lambda *s: torch.randn(*s, dtype=torch.bfloat16) * 0.8)(De, D)),
        "w_u": _w((lambda *s: torch.randn(*s, dtype=torch.bfloat16) * 0.05)(D, D)),
        "w_v": _w((lambda *s: torch.randn(*s, dtype=torch.bfloat16) * 0.05)(D, D)),
    }

def reference(x, e_attr, src, dst, w_a, w_b, w_c, w_u, w_v):
    N, D = x.shape
    hv = x @ w_v
    g = x[dst] @ w_a + x[src] @ w_b + e_attr @ w_c
    eta = _sigmoid(g)
    denom = _segment_sum(eta, dst, N) + 1e-6
    eta_n = eta / denom[dst]
    agg = _segment_sum(eta_n * hv[src], dst, N)
    z = x @ w_u + agg
    relu_z = torch.where(z > 0, z, 0 * z)
    return x + relu_z
```

```asm
; @launch kernel=k1_kernel grid=(255,1,1) block=(640,1,1) lds=44544
; @launch kernel=k3_kernel grid=(250,1,1) block=(512,1,1) lds=135168
.amdgcn_target "amdgcn-amd-amdhsa--gfx950"
.text
.globl k1_kernel
.p2align 8
.type k1_kernel,@function
k1_kernel:
  s_cmp_ge_u32 s2, 255
  s_cbranch_scc1 K1_END
  s_cmp_ge_u32 s2, 250
  s_cbranch_scc1 K1_PREP
  s_load_dwordx2 s[4:5], s[0:1], 24
  s_load_dwordx2 s[6:7], s[0:1], 88
  s_load_dwordx2 s[24:25], s[0:1], 16
  s_load_dwordx2 s[26:27], s[0:1], 8
  s_load_dwordx2 s[44:45], s[0:1], 0
  v_lshlrev_b32 v1, 2, v0
  v_mov_b32 v2, 0
  v_cmp_gt_u32 vcc, 256, v0
s_nop 0
  s_and_saveexec_b64 s[28:29], vcc
  ds_write_b32 v1, v2
  s_mov_b64 exec, s[28:29]
  v_lshlrev_b32 v3, 3, v0
  s_waitcnt lgkmcnt(0)
  s_mov_b32 s8, s4
  s_mov_b32 s9, s5
  s_mov_b32 s10, 3200000
  s_mov_b32 s11, 0x00020000
  s_mov_b32 s12, s24
  s_mov_b32 s13, s25
  s_mov_b32 s14, 3200000
  s_mov_b32 s15, 0x00020000
  s_mov_b32 s20, s26
  s_mov_b32 s21, s27
  s_mov_b32 s22, 6400000
  s_mov_b32 s23, 0x00020000
  s_mov_b32 s16, s6
  s_mov_b32 s17, s7
  s_mov_b32 s18, 13089280
  s_mov_b32 s19, 0x00020000
  s_mov_b32 s36, s6
  s_mov_b32 s37, s7
  s_mov_b32 s38, 13056000
  s_mov_b32 s39, 0x00020000
  s_mul_i32 s30, s2, 12800
  s_mul_i32 s31, s2, 25600
  s_add_u32 s32, s30, 0
  buffer_load_dword v10, v1, s[8:11], s32 offen nt
  s_add_u32 s32, s30, 2560
  buffer_load_dword v11, v1, s[8:11], s32 offen nt
  s_add_u32 s32, s30, 5120
  buffer_load_dword v12, v1, s[8:11], s32 offen nt
  s_add_u32 s32, s30, 7680
  buffer_load_dword v13, v1, s[8:11], s32 offen nt
  s_add_u32 s32, s30, 10240
  buffer_load_dword v14, v1, s[8:11], s32 offen nt
  s_add_u32 s32, s30, 0
  buffer_load_dword v16, v1, s[12:15], s32 offen nt
  s_add_u32 s33, s31, 0
  buffer_load_dwordx2 v[24:25], v3, s[20:23], s33 offen nt
  s_add_u32 s32, s30, 2560
  buffer_load_dword v17, v1, s[12:15], s32 offen nt
  s_add_u32 s33, s31, 5120
  buffer_load_dwordx2 v[26:27], v3, s[20:23], s33 offen nt
  s_add_u32 s32, s30, 5120
  buffer_load_dword v18, v1, s[12:15], s32 offen nt
  s_add_u32 s33, s31, 10240
  buffer_load_dwordx2 v[28:29], v3, s[20:23], s33 offen nt
  s_add_u32 s32, s30, 7680
  buffer_load_dword v19, v1, s[12:15], s32 offen nt
  s_add_u32 s33, s31, 15360
  buffer_load_dwordx2 v[30:31], v3, s[20:23], s33 offen nt
  s_add_u32 s32, s30, 10240
  buffer_load_dword v20, v1, s[12:15], s32 offen nt
  s_add_u32 s33, s31, 20480
  buffer_load_dwordx2 v[32:33], v3, s[20:23], s33 offen nt
  s_barrier
  s_mov_b32 s34, 21474837
  v_mov_b32 v4, 1
  s_waitcnt vmcnt(14)
  v_mul_hi_u32 v5, v10, s34
  v_mul_u32_u24 v6, 200, v5
  v_sub_u32 v6, v10, v6
  v_lshlrev_b32 v36, 2, v5
  ds_add_rtn_u32 v42, v36, v4
  v_mul_u32_u24 v7, 2622, v6
  v_lshrrev_b32 v7, 16, v7
  v_mul_u32_u24 v7, 25, v7
  v_sub_u32 v7, v6, v7
  v_cmp_lt_u32 vcc, 1, v7
s_nop 1
  v_cndmask_b32_e64 v8, 2, 4, vcc
  v_add_u32 v7, v7, v8
  v_lshlrev_b32 v7, 10, v7
  v_lshl_or_b32 v7, v6, 2, v7
  s_waitcnt vmcnt(9)
  v_lshl_or_b32 v77, v16, 16, v7
  v_mul_hi_u32 v5, v11, s34
  v_mul_u32_u24 v6, 200, v5
  v_sub_u32 v6, v11, v6
  v_lshlrev_b32 v37, 2, v5
  ds_add_rtn_u32 v43, v37, v4
  v_mul_u32_u24 v7, 2622, v6
  v_lshrrev_b32 v7, 16, v7
  v_mul_u32_u24 v7, 25, v7
  v_sub_u32 v7, v6, v7
  v_cmp_lt_u32 vcc, 1, v7
s_nop 1
  v_cndmask_b32_e64 v8, 2, 4, vcc
  v_add_u32 v7, v7, v8
  v_lshlrev_b32 v7, 10, v7
  v_lshl_or_b32 v7, v6, 2, v7
  s_waitcnt vmcnt(7)
  v_lshl_or_b32 v81, v17, 16, v7
  v_mul_hi_u32 v5, v12, s34
  v_mul_u32_u24 v6, 200, v5
  v_sub_u32 v6, v12, v6
  v_lshlrev_b32 v38, 2, v5
  ds_add_rtn_u32 v44, v38, v4
  v_mul_u32_u24 v7, 2622, v6
  v_lshrrev_b32 v7, 16, v7
  v_mul_u32_u24 v7, 25, v7
  v_sub_u32 v7, v6, v7
  v_cmp_lt_u32 vcc, 1, v7
s_nop 1
  v_cndmask_b32_e64 v8, 2, 4, vcc
  v_add_u32 v7, v7, v8
  v_lshlrev_b32 v7, 10, v7
  v_lshl_or_b32 v7, v6, 2, v7
  s_waitcnt vmcnt(5)
  v_lshl_or_b32 v85, v18, 16, v7
  v_mul_hi_u32 v5, v13, s34
  v_mul_u32_u24 v6, 200, v5
  v_sub_u32 v6, v13, v6
  v_lshlrev_b32 v39, 2, v5
  ds_add_rtn_u32 v45, v39, v4
  v_mul_u32_u24 v7, 2622, v6
  v_lshrrev_b32 v7, 16, v7
  v_mul_u32_u24 v7, 25, v7
  v_sub_u32 v7, v6, v7
  v_cmp_lt_u32 vcc, 1, v7
s_nop 1
  v_cndmask_b32_e64 v8, 2, 4, vcc
  v_add_u32 v7, v7, v8
  v_lshlrev_b32 v7, 10, v7
  v_lshl_or_b32 v7, v6, 2, v7
  s_waitcnt vmcnt(3)
  v_lshl_or_b32 v89, v19, 16, v7
  v_mul_hi_u32 v5, v14, s34
  v_mul_u32_u24 v6, 200, v5
  v_sub_u32 v6, v14, v6
  v_lshlrev_b32 v40, 2, v5
  ds_add_rtn_u32 v46, v40, v4
  v_mul_u32_u24 v7, 2622, v6
  v_lshrrev_b32 v7, 16, v7
  v_mul_u32_u24 v7, 25, v7
  v_sub_u32 v7, v6, v7
  v_cmp_lt_u32 vcc, 1, v7
s_nop 1
  v_cndmask_b32_e64 v8, 2, 4, vcc
  v_add_u32 v7, v7, v8
  v_lshlrev_b32 v7, 10, v7
  v_lshl_or_b32 v7, v6, 2, v7
  s_waitcnt vmcnt(1)
  v_lshl_or_b32 v93, v20, 16, v7
  s_waitcnt lgkmcnt(0)
  s_barrier
  v_and_b32 v60, 63, v0
  v_lshlrev_b32 v61, 4, v60
  ds_read_b128 v[64:67], v61
  s_waitcnt lgkmcnt(0)
  v_add_u32 v73, v64, v65
  v_add_u32 v74, v73, v66
  v_add_u32 v75, v74, v67
  v_mov_b32 v72, v75
s_nop 1
  v_add_u32_dpp v72, v72, v72 row_shr:1 row_mask:0xf bank_mask:0xf
s_nop 1
  v_add_u32_dpp v72, v72, v72 row_shr:2 row_mask:0xf bank_mask:0xf
s_nop 1
  v_add_u32_dpp v72, v72, v72 row_shr:4 row_mask:0xf bank_mask:0xf
s_nop 1
  v_add_u32_dpp v72, v72, v72 row_shr:8 row_mask:0xf bank_mask:0xf
s_nop 1
  v_add_u32_dpp v72, v72, v72 row_bcast:15 row_mask:0xa bank_mask:0xf
s_nop 1
  v_add_u32_dpp v72, v72, v72 row_bcast:31 row_mask:0xc bank_mask:0xf
  v_sub_u32 v68, v72, v75
  v_add_u32 v69, v68, v64
  v_add_u32 v70, v68, v73
  v_add_u32 v71, v68, v74
  ds_write_b128 v61, v[68:71] offset:1024
  v_lshrrev_b32 v62, 6, v0
s_nop 0
  v_readfirstlane_b32 s35, v62
s_nop 0
  s_cmp_lg_u32 s35, 0
  s_cbranch_scc1 K1_NODESC
  s_lshl_b32 s35, s2, 2
  s_add_u32 s35, s35, 12800000
  v_lshlrev_b32 v62, 12, v60
  v_lshl_or_b32 v96, v64, 16, v68
  buffer_store_dword v96, v62, s[36:39], s35 offen offset:0
  v_lshl_or_b32 v97, v65, 16, v69
  buffer_store_dword v97, v62, s[36:39], s35 offen offset:1024
  v_lshl_or_b32 v98, v66, 16, v70
  buffer_store_dword v98, v62, s[36:39], s35 offen offset:2048
  v_lshl_or_b32 v99, v67, 16, v71
  buffer_store_dword v99, v62, s[36:39], s35 offen offset:3072
K1_NODESC:
  s_mul_i32 s35, s2, 38400
  ds_read_b32 v60, v36 offset:1024
  ds_read_b32 v61, v37 offset:1024
  ds_read_b32 v62, v38 offset:1024
  ds_read_b32 v63, v39 offset:1024
  ds_read_b32 v64, v40 offset:1024
  s_waitcnt lgkmcnt(4)
  v_add_u32 v60, v60, v42
  v_mul_u32_u24 v60, 12, v60
  v_add_u32 v60, 2048, v60
  ds_write2_b32 v60, v24, v77 offset0:0 offset1:1
  ds_write_b32 v60, v25 offset:8
  s_waitcnt lgkmcnt(5)
  v_add_u32 v61, v61, v43
  v_mul_u32_u24 v61, 12, v61
  v_add_u32 v61, 2048, v61
  ds_write2_b32 v61, v26, v81 offset0:0 offset1:1
  ds_write_b32 v61, v27 offset:8
  s_waitcnt lgkmcnt(6)
  v_add_u32 v62, v62, v44
  v_mul_u32_u24 v62, 12, v62
  v_add_u32 v62, 2048, v62
  ds_write2_b32 v62, v28, v85 offset0:0 offset1:1
  ds_write_b32 v62, v29 offset:8
  s_waitcnt lgkmcnt(7)
  v_add_u32 v63, v63, v45
  v_mul_u32_u24 v63, 12, v63
  v_add_u32 v63, 2048, v63
  ds_write2_b32 v63, v30, v89 offset0:0 offset1:1
  ds_write_b32 v63, v31 offset:8
  s_waitcnt lgkmcnt(8)
  v_add_u32 v64, v64, v46
  v_mul_u32_u24 v64, 12, v64
  v_add_u32 v64, 2048, v64
  s_waitcnt vmcnt(0)
  ds_write2_b32 v64, v32, v93 offset0:0 offset1:1
  ds_write_b32 v64, v33 offset:8
  s_waitcnt lgkmcnt(0)
  s_barrier
  v_lshlrev_b32 v60, 4, v0
  ds_read_b128 v[100:103], v60 offset:2048
  ds_read_b128 v[104:107], v60 offset:12288
  ds_read_b128 v[108:111], v60 offset:22528
  ds_read_b128 v[112:115], v60 offset:32768
  s_mul_i32 s36, s2, 38400
  s_add_u32 s36, s36, 38400
  s_mov_b32 s37, 0x00020000
  s_mov_b32 s38, s36
  s_mov_b32 s39, s37
  s_mov_b32 s36, s16
  s_mov_b32 s37, s17
  s_add_u32 s33, s35, 0
  s_waitcnt lgkmcnt(3)
  buffer_store_dwordx4 v[100:103], v60, s[36:39], s33 offen sc0 sc1
  s_add_u32 s33, s35, 10240
  s_waitcnt lgkmcnt(2)
  buffer_store_dwordx4 v[104:107], v60, s[36:39], s33 offen sc0 sc1
  s_add_u32 s33, s35, 20480
  s_waitcnt lgkmcnt(1)
  buffer_store_dwordx4 v[108:111], v60, s[36:39], s33 offen sc0 sc1
  s_add_u32 s33, s35, 30720
  s_waitcnt lgkmcnt(0)
  buffer_store_dwordx4 v[112:115], v60, s[36:39], s33 offen sc0 sc1
  s_branch K1_END
K1_PREP:
  s_sub_u32 s40, s2, 250
  s_load_dwordx2 s[6:7], s[0:1], 88
  s_cmp_eq_u32 s40, 4
  s_cbranch_scc1 K1_PREP_WC
  s_mov_b32 s10, 40
  s_cmp_eq_u32 s40, 1
  s_cselect_b32 s10, 64, s10
  s_cmp_eq_u32 s40, 2
  s_cselect_b32 s10, 32, s10
  s_cmp_eq_u32 s40, 3
  s_cselect_b32 s10, 56, s10
  s_load_dwordx2 s[4:5], s[0:1], s10
  s_waitcnt lgkmcnt(0)
  s_mov_b32 s12, s4
  s_mov_b32 s13, s5
  s_mov_b32 s14, 8192
  s_mov_b32 s15, 0x00020000
  s_mov_b32 s16, s6
  s_mov_b32 s17, s7
  s_mov_b32 s18, 13089280
  s_mov_b32 s19, 0x00020000
  v_cmp_gt_u32 vcc, 512, v0
s_nop 0
  s_and_saveexec_b64 s[20:21], vcc
  s_cbranch_execz K1_END
  v_lshrrev_b32 v1, 7, v0
  v_bfe_u32 v2, v0, 6, 1
  v_and_b32 v3, 31, v0
  v_bfe_u32 v4, v0, 5, 1
  v_lshlrev_b32 v5, 4, v1
  v_lshl_add_u32 v5, v4, 3, v5
  v_lshlrev_b32 v5, 7, v5
  v_lshl_add_u32 v6, v3, 1, v2
  v_lshl_add_u32 v5, v6, 1, v5
  buffer_load_ushort v8, v5, s[12:15], 0 offen offset:0
  buffer_load_ushort v12, v5, s[12:15], 0 offen offset:128
  buffer_load_ushort v9, v5, s[12:15], 0 offen offset:256
  buffer_load_ushort v13, v5, s[12:15], 0 offen offset:384
  buffer_load_ushort v10, v5, s[12:15], 0 offen offset:512
  buffer_load_ushort v14, v5, s[12:15], 0 offen offset:640
  buffer_load_ushort v11, v5, s[12:15], 0 offen offset:768
  buffer_load_ushort v15, v5, s[12:15], 0 offen offset:896
  s_waitcnt vmcnt(6)
  v_lshl_or_b32 v8, v12, 16, v8
  s_waitcnt vmcnt(4)
  v_lshl_or_b32 v9, v13, 16, v9
  s_waitcnt vmcnt(2)
  v_lshl_or_b32 v10, v14, 16, v10
  s_waitcnt vmcnt(0)
  v_lshl_or_b32 v11, v15, 16, v11
  s_lshl_b32 s22, s40, 13
  s_add_u32 s22, s22, 13056000
  v_lshlrev_b32 v7, 4, v0
  buffer_store_dwordx4 v[8:11], v7, s[16:19], s22 offen
  s_branch K1_END
K1_PREP_WC:
  s_load_dwordx2 s[4:5], s[0:1], 48
  s_waitcnt lgkmcnt(0)
  s_mov_b32 s12, s4
  s_mov_b32 s13, s5
  s_mov_b32 s14, 512
  s_mov_b32 s15, 0x00020000
  s_mov_b32 s16, s6
  s_mov_b32 s17, s7
  s_mov_b32 s18, 13089280
  s_mov_b32 s19, 0x00020000
  v_cmp_gt_u32 vcc, 128, v0
s_nop 0
  s_and_saveexec_b64 s[20:21], vcc
  s_cbranch_execz K1_END
  v_bfe_u32 v2, v0, 6, 1
  v_and_b32 v3, 31, v0
  v_bfe_u32 v4, v0, 5, 1
  v_lshlrev_b32 v5, 8, v4
  v_lshl_add_u32 v6, v3, 1, v2
  v_lshl_add_u32 v5, v6, 1, v5
  buffer_load_ushort v8, v5, s[12:15], 0 offen
  buffer_load_ushort v9, v5, s[12:15], 0 offen offset:128
  s_waitcnt vmcnt(0)
  v_lshl_or_b32 v8, v9, 16, v8
  v_lshlrev_b32 v7, 2, v0
  s_mov_b32 s22, 13088768
  buffer_store_dword v8, v7, s[16:19], s22 offen
K1_END:
  s_endpgm
.globl k3_kernel
.p2align 8
.type k3_kernel,@function
k3_kernel:
  s_cmp_ge_u32 s2, 250
  s_cbranch_scc1 K3_END
  s_load_dwordx2 s[4:5], s[0:1], 0
  s_load_dwordx2 s[6:7], s[0:1], 88
  s_load_dwordx2 s[32:33], s[0:1], 72
  v_mov_b32 v95, v0
  v_lshrrev_b32 v86, 6, v0
  v_and_b32 v80, 63, v0
  v_readfirstlane_b32 s3, v86
  v_and_b32 v81, 31, v80
  v_lshrrev_b32 v82, 5, v80
  s_waitcnt lgkmcnt(0)
  s_mov_b32 s8, s4
  s_mov_b32 s9, s5
  s_mov_b32 s10, 6400000
  s_mov_b32 s11, 0x00020000
  s_mov_b32 s12, s6
  s_mov_b32 s13, s7
  s_mov_b32 s14, 13089280
  s_mov_b32 s15, 0x00020000
  s_mov_b32 s16, s32
  s_mov_b32 s17, s33
  s_mov_b32 s18, 6400000
  s_mov_b32 s19, 0x00020000
  v_lshlrev_b32 v93, 4, v80
  s_lshl_b32 s32, s3, 11
  s_add_u32 s33, s32, 13056000
  s_add_u32 m0, s32, 8192
s_nop 0
  buffer_load_dwordx4 v93, s[12:15], s33 offen lds
  s_add_u32 s33, s32, 13057024
  s_add_u32 m0, s32, 9216
s_nop 0
  buffer_load_dwordx4 v93, s[12:15], s33 offen lds
  s_lshl_b32 s32, s3, 10
  s_add_u32 s33, s32, 13072384
  s_add_u32 m0, s32, 24576
s_nop 0
  buffer_load_dwordx4 v93, s[12:15], s33 offen lds
  s_mul_i32 s32, s2, 1024
  s_add_u32 s32, s32, 12800000
  s_mov_b32 s40, s6
  s_mov_b32 s41, s7
  s_mov_b32 s42, 0
  s_mov_b32 s43, 0x00020000
  s_add_u32 s42, s32, 1000
  v_lshlrev_b32 v88, 4, v80
  buffer_load_dwordx4 v[244:247], v88, s[40:43], s32 offen
  s_lshl_b32 s33, s3, 1
  v_add_u32 v86, s33, v82
  v_lshlrev_b32 v72, 2, v86
  v_mul_u32_u24 v86, 3200, v86
  v_add_u32 v86, v86, v81
  v_mul_u32_u24 v94, 12, v86
  v_lshlrev_b32 v86, 2, v80
  s_mov_b32 s37, 13088768
  buffer_load_dword v64, v86, s[12:15], s37 offen offset:0
  buffer_load_dword v68, v86, s[12:15], s37 offen offset:256
  v_lshrrev_b32 v83, 3, v81
  v_and_b32 v84, 7, v81
  s_mov_b32 s20, 0xbfb8aa3b
  s_mov_b32 s21, 0x3ff
  s_mov_b32 s22, 0x358637bd
  s_mov_b32 s23, 0xffff0000
  s_mov_b32 s24, 0x78
  s_mov_b32 s36, 0x1fffffcc
  s_mul_i32 s27, s3, 8448
  s_add_u32 s27, s27, 67584
  v_lshrrev_b32 v86, 4, v80
  v_and_b32 v86, 1, v86
  v_and_b32 v87, 7, v80
  v_xor_b32 v86, v86, v87
  v_lshlrev_b32 v232, 4, v86
  v_lshrrev_b32 v86, 1, v84
  v_and_b32 v86, 1, v86
  v_xor_b32 v86, v86, v82
  v_lshlrev_b32 v86, 4, v86
  v_lshl_add_u32 v86, v84, 7, v86
  v_mul_u32_u24 v87, 1056, v83
  v_add3_u32 v233, v86, v87, s27
  v_lshlrev_b32 v238, 10, v82
  v_subrev_u32 v85, 4, v81
  v_subrev_u32 v86, 2, v81
  v_cmp_gt_u32 vcc, 4, v81
s_nop 1
  v_cndmask_b32 v85, v85, v86, vcc
  s_mov_b32 s60, 0xbfb8aa3b
  s_mov_b32 s61, 0xbfb8aa3b
  s_mov_b32 s62, 1.0
  s_mov_b32 s63, 1.0
  v_lshlrev_b32 v86, 2, v95
  v_mov_b32 v87, 0
  v_cmp_gt_u32 vcc, 256, v95
s_nop 0
  s_and_saveexec_b64 s[44:45], vcc
  ds_write_b32 v86, v87 offset:2304
  s_mov_b64 exec, s[44:45]
  s_cmp_lg_u32 s3, 0
  s_cbranch_scc1 K3_TBL_DONE
  v_mov_b32 v86, 0
  v_mov_b32 v87, 0
  v_mov_b32 v88, 0
  v_mov_b32 v89, 0
  v_lshlrev_b32 v90, 4, v80
  ds_write_b128 v90, v[86:89] offset:0
  ds_write_b128 v90, v[86:89] offset:1024
  v_lshrrev_b32 v90, 2, v80
  v_and_b32 v90, 1, v90
  v_lshlrev_b32 v90, 10, v90
  v_lshl_add_u32 v90, v80, 5, v90
  v_lshrrev_b32 v91, 4, v80
  v_and_b32 v91, 1, v91
  v_lshl_add_u32 v90, v91, 4, v90
  v_lshrrev_b32 v91, 3, v80
  v_and_b32 v91, 1, v91
  v_lshl_add_u32 v90, v91, 3, v90
  v_and_b32 v91, 3, v80
  v_lshl_add_u32 v90, v91, 1, v90
  v_mov_b32 v91, 0x3f80
  s_mov_b32 exec_hi, 0
  ds_write_b16 v90, v91 offset:0
  s_mov_b64 exec, 0xffff
  v_bfe_i32 v90, v80, 0, 1
  v_and_b32 v90, 0x3f80, v90
  v_bfe_i32 v91, v80, 1, 1
  v_and_b32 v91, 0x3f800000, v91
  v_or_b32 v92, v90, v91
  v_bfe_i32 v90, v80, 2, 1
  v_and_b32 v90, 0x3f80, v90
  v_bfe_i32 v91, v80, 3, 1
  v_and_b32 v91, 0x3f800000, v91
  v_or_b32 v93, v90, v91
  v_lshlrev_b32 v90, 3, v80
  ds_write_b64 v90, v[92:93] offset:2048
  s_mov_b64 exec, -1
K3_TBL_DONE:
  v_lshlrev_b32 v88, 4, v80
  s_waitcnt vmcnt(2)
  ds_write_b128 v88, v[244:247] offset:4384
  s_waitcnt lgkmcnt(0)
  ds_read_b32 v224, v72 offset:4384
  ds_read_b32 v225, v72 offset:4448
  ds_read_b32 v226, v72 offset:4512
  ds_read_b32 v227, v72 offset:4576
  ds_read_b32 v228, v72 offset:4640
  ds_read_b32 v229, v72 offset:4704
  ds_read_b32 v230, v72 offset:4768
  ds_read_b32 v231, v72 offset:4832
  ds_read_b32 v248, v72 offset:4896
  ds_read_b32 v249, v72 offset:4960
  ds_read_b32 v250, v72 offset:5024
  ds_read_b32 v251, v72 offset:5088
  ds_read_b32 v252, v72 offset:5152
  ds_read_b32 v253, v72 offset:5216
  ds_read_b32 v254, v72 offset:5280
  ds_read_b32 v255, v72 offset:5344
  s_mov_b32 s32, 0
  s_waitcnt lgkmcnt(15)
  v_lshrrev_b32 v87, 16, v224
  v_cmp_lt_u32 s[64:65], v81, v87
  v_and_b32 v224, 0xffff, v224
  v_mad_u32_u24 v224, v224, 12, v94
  s_mov_b64 exec, s[64:65]
  buffer_load_dwordx3 v[144:146], v224, s[12:15], s32 offen
  s_mov_b64 exec, -1
  s_add_u32 s32, s32, 614400
  s_waitcnt lgkmcnt(14)
  v_lshrrev_b32 v87, 16, v225
  v_cmp_lt_u32 s[66:67], v81, v87
  v_and_b32 v225, 0xffff, v225
  v_mad_u32_u24 v225, v225, 12, v94
  s_mov_b64 exec, s[66:67]
  buffer_load_dwordx3 v[148:150], v225, s[12:15], s32 offen
  s_mov_b64 exec, -1
  s_add_u32 s32, s32, 614400
  s_waitcnt lgkmcnt(13)
  v_lshrrev_b32 v87, 16, v226
  v_cmp_lt_u32 s[68:69], v81, v87
  v_and_b32 v226, 0xffff, v226
  v_mad_u32_u24 v226, v226, 12, v94
  s_mov_b64 exec, s[68:69]
  buffer_load_dwordx3 v[152:154], v226, s[12:15], s32 offen
  s_mov_b64 exec, -1
  s_add_u32 s32, s32, 614400
  s_waitcnt lgkmcnt(12)
  v_lshrrev_b32 v87, 16, v227
  v_cmp_lt_u32 s[70:71], v81, v87
  v_and_b32 v227, 0xffff, v227
  v_mad_u32_u24 v227, v227, 12, v94
  s_mov_b64 exec, s[70:71]
  buffer_load_dwordx3 v[156:158], v227, s[12:15], s32 offen
  s_mov_b64 exec, -1
  s_add_u32 s32, s32, 614400
  s_waitcnt lgkmcnt(11)
  v_lshrrev_b32 v87, 16, v228
  v_cmp_lt_u32 s[72:73], v81, v87
  v_and_b32 v228, 0xffff, v228
  v_mad_u32_u24 v228, v228, 12, v94
  s_mov_b64 exec, s[72:73]
  buffer_load_dwordx3 v[160:162], v228, s[12:15], s32 offen
  s_mov_b64 exec, -1
  s_add_u32 s32, s32, 614400
  s_waitcnt lgkmcnt(10)
  v_lshrrev_b32 v87, 16, v229
  v_cmp_lt_u32 s[74:75], v81, v87
  v_and_b32 v229, 0xffff, v229
  v_mad_u32_u24 v229, v229, 12, v94
  s_mov_b64 exec, s[74:75]
  buffer_load_dwordx3 v[164:166], v229, s[12:15], s32 offen
  s_mov_b64 exec, -1
  s_add_u32 s32, s32, 614400
  s_waitcnt lgkmcnt(9)
  v_lshrrev_b32 v87, 16, v230
  v_cmp_lt_u32 s[76:77], v81, v87
  v_and_b32 v230, 0xffff, v230
  v_mad_u32_u24 v230, v230, 12, v94
  s_mov_b64 exec, s[76:77]
  buffer_load_dwordx3 v[168:170], v230, s[12:15], s32 offen
  s_mov_b64 exec, -1
  s_add_u32 s32, s32, 614400
  s_waitcnt lgkmcnt(8)
  v_lshrrev_b32 v87, 16, v231
  v_cmp_lt_u32 s[78:79], v81, v87
  v_and_b32 v231, 0xffff, v231
  v_mad_u32_u24 v231, v231, 12, v94
  s_mov_b64 exec, s[78:79]
  buffer_load_dwordx3 v[172:174], v231, s[12:15], s32 offen
  s_mov_b64 exec, -1
  s_add_u32 s32, s32, 614400
  s_waitcnt lgkmcnt(7)
  v_lshrrev_b32 v87, 16, v248
  v_cmp_lt_u32 s[80:81], v81, v87
  v_and_b32 v248, 0xffff, v248
  v_mad_u32_u24 v248, v248, 12, v94
  s_mov_b64 exec, s[80:81]
  buffer_load_dwordx3 v[176:178], v248, s[12:15], s32 offen
  s_mov_b64 exec, -1
  s_add_u32 s32, s32, 614400
  s_waitcnt lgkmcnt(6)
  v_lshrrev_b32 v87, 16, v249
  v_cmp_lt_u32 s[82:83], v81, v87
  v_and_b32 v249, 0xffff, v249
  v_mad_u32_u24 v249, v249, 12, v94
  s_mov_b64 exec, s[82:83]
  buffer_load_dwordx3 v[180:182], v249, s[12:15], s32 offen
  s_mov_b64 exec, -1
  s_add_u32 s32, s32, 614400
  s_waitcnt lgkmcnt(5)
  v_lshrrev_b32 v87, 16, v250
  v_cmp_lt_u32 s[84:85], v81, v87
  v_and_b32 v250, 0xffff, v250
  v_mad_u32_u24 v250, v250, 12, v94
  s_mov_b64 exec, s[84:85]
  buffer_load_dwordx3 v[184:186], v250, s[12:15], s32 offen
  s_mov_b64 exec, -1
  s_add_u32 s32, s32, 614400
  s_waitcnt lgkmcnt(4)
  v_lshrrev_b32 v87, 16, v251
  v_cmp_lt_u32 s[86:87], v81, v87
  v_and_b32 v251, 0xffff, v251
  v_mad_u32_u24 v251, v251, 12, v94
  s_mov_b64 exec, s[86:87]
  buffer_load_dwordx3 v[188:190], v251, s[12:15], s32 offen
  s_mov_b64 exec, -1
  s_add_u32 s32, s32, 614400
  s_waitcnt lgkmcnt(3)
  v_lshrrev_b32 v87, 16, v252
  v_cmp_lt_u32 s[88:89], v81, v87
  v_and_b32 v252, 0xffff, v252
  v_mad_u32_u24 v252, v252, 12, v94
  s_mov_b64 exec, s[88:89]
  buffer_load_dwordx3 v[192:194], v252, s[12:15], s32 offen
  s_mov_b64 exec, -1
  s_add_u32 s32, s32, 614400
  s_waitcnt lgkmcnt(2)
  v_lshrrev_b32 v87, 16, v253
  v_cmp_lt_u32 s[90:91], v81, v87
  v_and_b32 v253, 0xffff, v253
  v_mad_u32_u24 v253, v253, 12, v94
  s_mov_b64 exec, s[90:91]
  buffer_load_dwordx3 v[196:198], v253, s[12:15], s32 offen
  s_mov_b64 exec, -1
  s_add_u32 s32, s32, 614400
  s_waitcnt lgkmcnt(1)
  v_lshrrev_b32 v87, 16, v254
  v_cmp_lt_u32 s[92:93], v81, v87
  v_and_b32 v254, 0xffff, v254
  v_mad_u32_u24 v254, v254, 12, v94
  s_mov_b64 exec, s[92:93]
  buffer_load_dwordx3 v[200:202], v254, s[12:15], s32 offen
  s_mov_b64 exec, -1
  s_add_u32 s32, s32, 614400
  s_waitcnt lgkmcnt(0)
  v_lshrrev_b32 v87, 16, v255
  v_cmp_lt_u32 s[94:95], v81, v87
  v_and_b32 v255, 0xffff, v255
  v_mad_u32_u24 v255, v255, 12, v94
  s_mov_b64 exec, s[94:95]
  buffer_load_dwordx3 v[204:206], v255, s[12:15], s32 offen
  s_mov_b64 exec, -1
  v_lshrrev_b32 v96, 16, v244
  v_lshrrev_b32 v97, 16, v245
  v_lshrrev_b32 v98, 16, v246
  v_lshrrev_b32 v99, 16, v247
  v_add_u32 v100, v96, v97
  v_add3_u32 v100, v100, v98, v99
  v_max_u32 v101, v96, v97
  v_max3_u32 v101, v101, v98, v99
  v_add_u32_dpp v100, v100, v100 row_shr:1 row_mask:0xf bank_mask:0xf
s_nop 0
  v_max_u32_dpp v101, v101, v101 row_shr:1 row_mask:0xf bank_mask:0xf
  v_add_u32_dpp v100, v100, v100 row_shr:2 row_mask:0xf bank_mask:0xf
s_nop 0
  v_max_u32_dpp v101, v101, v101 row_shr:2 row_mask:0xf bank_mask:0xf
  v_add_u32_dpp v100, v100, v100 row_shr:4 row_mask:0xf bank_mask:0xf
s_nop 0
  v_max_u32_dpp v101, v101, v101 row_shr:4 row_mask:0xf bank_mask:0xf
  v_add_u32_dpp v100, v100, v100 row_shr:8 row_mask:0xf bank_mask:0xf
s_nop 0
  v_max_u32_dpp v101, v101, v101 row_shr:8 row_mask:0xf bank_mask:0xf
  v_add_u32_dpp v100, v100, v100 row_bcast:15 row_mask:0xa bank_mask:0xf
s_nop 0
  v_max_u32_dpp v101, v101, v101 row_bcast:15 row_mask:0xa bank_mask:0xf
  v_add_u32_dpp v100, v100, v100 row_bcast:31 row_mask:0xc bank_mask:0xf
s_nop 0
  v_max_u32_dpp v101, v101, v101 row_bcast:31 row_mask:0xc bank_mask:0xf
  v_readlane_b32 s31, v100, 63
  v_readlane_b32 s49, v101, 63
  s_waitcnt lgkmcnt(0)
  s_barrier
  v_lshlrev_b32 v93, 4, v80
  v_add_u32 v93, 8192, v93
  ds_read_b128 v[112:115], v93 offset:16384
  ds_read_b128 v[116:119], v93 offset:17408
  ds_read_b128 v[120:123], v93 offset:18432
  ds_read_b128 v[124:127], v93 offset:19456
  ds_read_b128 v[128:131], v93 offset:20480
  ds_read_b128 v[132:135], v93 offset:21504
  ds_read_b128 v[136:139], v93 offset:22528
  ds_read_b128 v[140:143], v93 offset:23552
  ds_read_b128 v[0:3], v93 offset:0
  ds_read_b128 v[32:35], v93 offset:8192
  ds_read_b128 v[4:7], v93 offset:1024
  ds_read_b128 v[36:39], v93 offset:9216
  ds_read_b128 v[8:11], v93 offset:2048
  ds_read_b128 v[40:43], v93 offset:10240
  ds_read_b128 v[12:15], v93 offset:3072
  ds_read_b128 v[44:47], v93 offset:11264
  ds_read_b128 v[16:19], v93 offset:4096
  ds_read_b128 v[48:51], v93 offset:12288
  ds_read_b128 v[20:23], v93 offset:5120
  ds_read_b128 v[52:55], v93 offset:13312
  ds_read_b128 v[24:27], v93 offset:6144
  ds_read_b128 v[56:59], v93 offset:14336
  ds_read_b128 v[28:31], v93 offset:7168
  ds_read_b128 v[60:63], v93 offset:15360
  s_cmp_gt_u32 s31, 3584
  s_cbranch_scc1 K3_SLOW
  s_cmp_gt_u32 s49, 32
  s_cbranch_scc1 K3_SLOW
  v_mov_b32 v87, 1
  s_mov_b64 exec, s[64:65]
  s_waitcnt vmcnt(0)
  v_and_b32 v88, 0x3fc, v145
  ds_add_rtn_u32 v224, v88, v87 offset:2304
  s_mov_b64 exec, s[66:67]
  v_and_b32 v88, 0x3fc, v149
  ds_add_rtn_u32 v225, v88, v87 offset:2304
  s_mov_b64 exec, s[68:69]
  v_and_b32 v88, 0x3fc, v153
  ds_add_rtn_u32 v226, v88, v87 offset:2304
  s_mov_b64 exec, s[70:71]
  v_and_b32 v88, 0x3fc, v157
  ds_add_rtn_u32 v227, v88, v87 offset:2304
  s_mov_b64 exec, s[72:73]
  v_and_b32 v88, 0x3fc, v161
  ds_add_rtn_u32 v228, v88, v87 offset:2304
  s_mov_b64 exec, s[74:75]
  v_and_b32 v88, 0x3fc, v165
  ds_add_rtn_u32 v229, v88, v87 offset:2304
  s_mov_b64 exec, s[76:77]
  v_and_b32 v88, 0x3fc, v169
  ds_add_rtn_u32 v230, v88, v87 offset:2304
  s_mov_b64 exec, s[78:79]
  v_and_b32 v88, 0x3fc, v173
  ds_add_rtn_u32 v231, v88, v87 offset:2304
  s_mov_b64 exec, s[80:81]
  v_and_b32 v88, 0x3fc, v177
  ds_add_rtn_u32 v248, v88, v87 offset:2304
  s_mov_b64 exec, s[82:83]
  v_and_b32 v88, 0x3fc, v181
  ds_add_rtn_u32 v249, v88, v87 offset:2304
  s_mov_b64 exec, s[84:85]
  v_and_b32 v88, 0x3fc, v185
  ds_add_rtn_u32 v250, v88, v87 offset:2304
  s_mov_b64 exec, s[86:87]
  v_and_b32 v88, 0x3fc, v189
  ds_add_rtn_u32 v251, v88, v87 offset:2304
  s_mov_b64 exec, s[88:89]
  v_and_b32 v88, 0x3fc, v193
  ds_add_rtn_u32 v252, v88, v87 offset:2304
  s_mov_b64 exec, s[90:91]
  v_and_b32 v88, 0x3fc, v197
  ds_add_rtn_u32 v253, v88, v87 offset:2304
  s_mov_b64 exec, s[92:93]
  v_and_b32 v88, 0x3fc, v201
  ds_add_rtn_u32 v254, v88, v87 offset:2304
  s_mov_b64 exec, s[94:95]
  v_and_b32 v88, 0x3fc, v205
  ds_add_rtn_u32 v255, v88, v87 offset:2304
  s_mov_b64 exec, -1
  s_waitcnt lgkmcnt(0)
  s_barrier
  v_lshlrev_b32 v86, 4, v80
  ds_read_b128 v[208:211], v86 offset:2304
  s_waitcnt lgkmcnt(0)
  v_add_u32 v217, v208, v209
  v_add_u32 v218, v217, v210
  v_add_u32 v219, v218, v211
  v_mov_b32 v216, v219
s_nop 1
  v_add_u32_dpp v216, v216, v216 row_shr:1 row_mask:0xf bank_mask:0xf
s_nop 1
  v_add_u32_dpp v216, v216, v216 row_shr:2 row_mask:0xf bank_mask:0xf
s_nop 1
  v_add_u32_dpp v216, v216, v216 row_shr:4 row_mask:0xf bank_mask:0xf
s_nop 1
  v_add_u32_dpp v216, v216, v216 row_shr:8 row_mask:0xf bank_mask:0xf
s_nop 1
  v_add_u32_dpp v216, v216, v216 row_bcast:15 row_mask:0xa bank_mask:0xf
s_nop 1
  v_add_u32_dpp v216, v216, v216 row_bcast:31 row_mask:0xc bank_mask:0xf
  v_sub_u32 v212, v216, v219
  v_add_u32 v213, v212, v208
  v_add_u32 v214, v212, v217
  v_add_u32 v215, v212, v218
  ds_write_b128 v86, v[212:215] offset:3328
  s_mul_i32 s32, s31, 1
  s_lshr_b32 s32, s32, 3
  v_cmp_gt_u32 s[44:45], s32, v212
  v_cmp_gt_u32 s[46:47], s32, v213
  v_cmp_gt_u32 s[48:49], s32, v214
  v_cmp_gt_u32 vcc, s32, v215
  s_bcnt1_i32_b64 s44, s[44:45]
  s_bcnt1_i32_b64 s46, s[46:47]
  s_bcnt1_i32_b64 s48, s[48:49]
  s_bcnt1_i32_b64 s33, vcc
  s_add_u32 s96, s44, s46
  s_add_u32 s96, s96, s48
  s_add_u32 s96, s96, s33
  s_mul_i32 s32, s31, 2
  s_lshr_b32 s32, s32, 3
  v_cmp_gt_u32 s[44:45], s32, v212
  v_cmp_gt_u32 s[46:47], s32, v213
  v_cmp_gt_u32 s[48:49], s32, v214
  v_cmp_gt_u32 vcc, s32, v215
  s_bcnt1_i32_b64 s44, s[44:45]
  s_bcnt1_i32_b64 s46, s[46:47]
  s_bcnt1_i32_b64 s48, s[48:49]
  s_bcnt1_i32_b64 s33, vcc
  s_add_u32 s97, s44, s46
  s_add_u32 s97, s97, s48
  s_add_u32 s97, s97, s33
  s_mul_i32 s32, s31, 3
  s_lshr_b32 s32, s32, 3
  v_cmp_gt_u32 s[44:45], s32, v212
  v_cmp_gt_u32 s[46:47], s32, v213
  v_cmp_gt_u32 s[48:49], s32, v214
  v_cmp_gt_u32 vcc, s32, v215
  s_bcnt1_i32_b64 s44, s[44:45]
  s_bcnt1_i32_b64 s46, s[46:47]
  s_bcnt1_i32_b64 s48, s[48:49]
  s_bcnt1_i32_b64 s33, vcc
  s_add_u32 s98, s44, s46
  s_add_u32 s98, s98, s48
  s_add_u32 s98, s98, s33
  s_mul_i32 s32, s31, 4
  s_lshr_b32 s32, s32, 3
  v_cmp_gt_u32 s[44:45], s32, v212
  v_cmp_gt_u32 s[46:47], s32, v213
  v_cmp_gt_u32 s[48:49], s32, v214
  v_cmp_gt_u32 vcc, s32, v215
  s_bcnt1_i32_b64 s44, s[44:45]
  s_bcnt1_i32_b64 s46, s[46:47]
  s_bcnt1_i32_b64 s48, s[48:49]
  s_bcnt1_i32_b64 s33, vcc
  s_add_u32 s99, s44, s46
  s_add_u32 s99, s99, s48
  s_add_u32 s99, s99, s33
  s_mul_i32 s32, s31, 5
  s_lshr_b32 s32, s32, 3
  v_cmp_gt_u32 s[44:45], s32, v212
  v_cmp_gt_u32 s[46:47], s32, v213
  v_cmp_gt_u32 s[48:49], s32, v214
  v_cmp_gt_u32 vcc, s32, v215
  s_bcnt1_i32_b64 s44, s[44:45]
  s_bcnt1_i32_b64 s46, s[46:47]
  s_bcnt1_i32_b64 s48, s[48:49]
  s_bcnt1_i32_b64 s33, vcc
  s_add_u32 s100, s44, s46
  s_add_u32 s100, s100, s48
  s_add_u32 s100, s100, s33
  s_mul_i32 s32, s31, 6
  s_lshr_b32 s32, s32, 3
  v_cmp_gt_u32 s[44:45], s32, v212
  v_cmp_gt_u32 s[46:47], s32, v213
  v_cmp_gt_u32 s[48:49], s32, v214
  v_cmp_gt_u32 vcc, s32, v215
  s_bcnt1_i32_b64 s44, s[44:45]
  s_bcnt1_i32_b64 s46, s[46:47]
  s_bcnt1_i32_b64 s48, s[48:49]
  s_bcnt1_i32_b64 s33, vcc
  s_add_u32 s101, s44, s46
  s_add_u32 s101, s101, s48
  s_add_u32 s101, s101, s33
  s_mul_i32 s32, s31, 7
  s_lshr_b32 s32, s32, 3
  v_cmp_gt_u32 s[44:45], s32, v212
  v_cmp_gt_u32 s[46:47], s32, v213
  v_cmp_gt_u32 s[48:49], s32, v214
  v_cmp_gt_u32 vcc, s32, v215
  s_bcnt1_i32_b64 s44, s[44:45]
  s_bcnt1_i32_b64 s46, s[46:47]
  s_bcnt1_i32_b64 s48, s[48:49]
  s_bcnt1_i32_b64 s33, vcc
  s_add_u32 s30, s44, s46
  s_add_u32 s30, s30, s48
  s_add_u32 s30, s30, s33
  s_max_u32 s96, s96, 4
  s_min_u32 s96, s96, 28
  s_max_u32 s97, s97, 32
  s_add_u32 s32, s96, 28
  s_min_u32 s97, s97, s32
  s_max_u32 s98, s98, 60
  s_add_u32 s32, s97, 28
  s_min_u32 s98, s98, s32
  s_max_u32 s99, s99, 88
  s_add_u32 s32, s98, 28
  s_min_u32 s99, s99, s32
  s_max_u32 s100, s100, 116
  s_add_u32 s32, s99, 28
  s_min_u32 s100, s100, s32
  s_max_u32 s101, s101, 144
  s_add_u32 s32, s100, 28
  s_min_u32 s101, s101, s32
  s_max_u32 s30, s30, 172
  s_add_u32 s32, s101, 28
  s_min_u32 s30, s30, s32
  s_mov_b32 s34, 0
  s_mov_b32 s35, s96
  s_cmp_eq_u32 s3, 1
  s_cselect_b32 s34, s96, s34
  s_cselect_b32 s35, s97, s35
  s_cmp_eq_u32 s3, 2
  s_cselect_b32 s34, s97, s34
  s_cselect_b32 s35, s98, s35
  s_cmp_eq_u32 s3, 3
  s_cselect_b32 s34, s98, s34
  s_cselect_b32 s35, s99, s35
  s_cmp_eq_u32 s3, 4
  s_cselect_b32 s34, s99, s34
  s_cselect_b32 s35, s100, s35
  s_cmp_eq_u32 s3, 5
  s_cselect_b32 s34, s100, s34
  s_cselect_b32 s35, s101, s35
  s_cmp_eq_u32 s3, 6
  s_cselect_b32 s34, s101, s34
  s_cselect_b32 s35, s30, s35
  s_cmp_eq_u32 s3, 7
  s_cselect_b32 s34, s30, s34
  s_cselect_b32 s35, 200, s35
  s_sub_u32 s35, s35, s34
  s_min_u32 s32, s35, 2
  s_lshl_b32 s33, 4, s32
  s_sub_u32 s36, s33, 4
  s_max_u32 s32, s35, 2
  s_sub_u32 s32, s32, 2
  s_bfm_b32 s33, s32, 6
  s_or_b32 s36, s36, s33
  s_mul_i32 s32, s2, 200
  s_add_u32 s32, s32, s34
  v_lshrrev_b32 v86, 3, v80
  v_mov_b32 v89, 0x80000000
  v_add_u32 v87, 0, v86
  v_subrev_u32 v88, 2, v87
  v_subrev_u32 v90, 4, v87
  v_cmp_gt_u32 vcc, 4, v87
s_nop 1
  v_cndmask_b32 v88, v90, v88, vcc
  v_add_u32 v88, s32, v88
  v_lshl_add_u32 v240, v88, 7, v232
  v_lshrrev_b32 v88, v87, s36
  v_and_b32 v88, 1, v88
  v_cmp_eq_u32 vcc, 1, v88
s_nop 1
  v_cndmask_b32 v240, v89, v240, vcc
  v_add_u32 v87, 8, v86
  v_subrev_u32 v88, 4, v87
  v_add_u32 v88, s32, v88
  v_lshl_add_u32 v241, v88, 7, v232
  v_lshrrev_b32 v88, v87, s36
  v_and_b32 v88, 1, v88
  v_cmp_eq_u32 vcc, 1, v88
s_nop 1
  v_cndmask_b32 v241, v89, v241, vcc
  v_add_u32 v87, 16, v86
  v_subrev_u32 v88, 4, v87
  v_add_u32 v88, s32, v88
  v_lshl_add_u32 v242, v88, 7, v232
  v_lshrrev_b32 v88, v87, s36
  v_and_b32 v88, 1, v88
  v_cmp_eq_u32 vcc, 1, v88
s_nop 1
  v_cndmask_b32 v242, v89, v242, vcc
  v_add_u32 v87, 24, v86
  v_subrev_u32 v88, 4, v87
  v_add_u32 v88, s32, v88
  v_lshl_add_u32 v243, v88, 7, v232
  v_lshrrev_b32 v88, v87, s36
  v_and_b32 v88, 1, v88
  v_cmp_eq_u32 vcc, 1, v88
s_nop 1
  v_cndmask_b32 v243, v89, v243, vcc
  s_add_u32 m0, s27, 4224
s_nop 0
  buffer_load_dwordx4 v240, s[8:11], 0 offen lds
  s_add_u32 m0, s27, 5280
s_nop 0
  buffer_load_dwordx4 v241, s[8:11], 0 offen lds
  s_add_u32 m0, s27, 6336
s_nop 0
  buffer_load_dwordx4 v242, s[8:11], 0 offen lds
  s_add_u32 m0, s27, 7392
s_nop 0
  buffer_load_dwordx4 v243, s[8:11], 0 offen lds
  v_lshlrev_b32 v104, 2, v80
  v_mov_b32 v96, v212
  v_add_u32 v108, 0, v104
  v_mov_b32 v97, 0
  v_mov_b32 v98, v213
  v_add_u32 v109, 1, v104
  v_mov_b32 v99, 0
  v_mov_b32 v100, v214
  v_add_u32 v110, 2, v104
  v_mov_b32 v101, 0
  v_mov_b32 v102, v215
  v_add_u32 v111, 3, v104
  v_mov_b32 v103, 0
  v_mov_b32 v106, s96
  v_cmp_le_u32 s[44:45], s96, v108
  v_cmp_le_u32 s[46:47], s96, v109
  v_cmp_le_u32 s[48:49], s96, v110
  v_cmp_le_u32 vcc, s96, v111
  v_cndmask_b32_e64 v97, v97, v106, s[44:45]
  v_cndmask_b32_e64 v99, v99, v106, s[46:47]
  v_cndmask_b32_e64 v101, v101, v106, s[48:49]
  v_cndmask_b32 v103, v103, v106, vcc
  v_mov_b32 v106, s97
  v_cmp_le_u32 s[44:45], s97, v108
  v_cmp_le_u32 s[46:47], s97, v109
  v_cmp_le_u32 s[48:49], s97, v110
  v_cmp_le_u32 vcc, s97, v111
  v_cndmask_b32_e64 v97, v97, v106, s[44:45]
  v_cndmask_b32_e64 v99, v99, v106, s[46:47]
  v_cndmask_b32_e64 v101, v101, v106, s[48:49]
  v_cndmask_b32 v103, v103, v106, vcc
  v_mov_b32 v106, s98
  v_cmp_le_u32 s[44:45], s98, v108
  v_cmp_le_u32 s[46:47], s98, v109
  v_cmp_le_u32 s[48:49], s98, v110
  v_cmp_le_u32 vcc, s98, v111
  v_cndmask_b32_e64 v97, v97, v106, s[44:45]
  v_cndmask_b32_e64 v99, v99, v106, s[46:47]
  v_cndmask_b32_e64 v101, v101, v106, s[48:49]
  v_cndmask_b32 v103, v103, v106, vcc
  v_mov_b32 v106, s99
  v_cmp_le_u32 s[44:45], s99, v108
  v_cmp_le_u32 s[46:47], s99, v109
  v_cmp_le_u32 s[48:49], s99, v110
  v_cmp_le_u32 vcc, s99, v111
  v_cndmask_b32_e64 v97, v97, v106, s[44:45]
  v_cndmask_b32_e64 v99, v99, v106, s[46:47]
  v_cndmask_b32_e64 v101, v101, v106, s[48:49]
  v_cndmask_b32 v103, v103, v106, vcc
  v_mov_b32 v106, s100
  v_cmp_le_u32 s[44:45], s100, v108
  v_cmp_le_u32 s[46:47], s100, v109
  v_cmp_le_u32 s[48:49], s100, v110
  v_cmp_le_u32 vcc, s100, v111
  v_cndmask_b32_e64 v97, v97, v106, s[44:45]
  v_cndmask_b32_e64 v99, v99, v106, s[46:47]
  v_cndmask_b32_e64 v101, v101, v106, s[48:49]
  v_cndmask_b32 v103, v103, v106, vcc
  v_mov_b32 v106, s101
  v_cmp_le_u32 s[44:45], s101, v108
  v_cmp_le_u32 s[46:47], s101, v109
  v_cmp_le_u32 s[48:49], s101, v110
  v_cmp_le_u32 vcc, s101, v111
  v_cndmask_b32_e64 v97, v97, v106, s[44:45]
  v_cndmask_b32_e64 v99, v99, v106, s[46:47]
  v_cndmask_b32_e64 v101, v101, v106, s[48:49]
  v_cndmask_b32 v103, v103, v106, vcc
  v_mov_b32 v106, s30
  v_cmp_le_u32 s[44:45], s30, v108
  v_cmp_le_u32 s[46:47], s30, v109
  v_cmp_le_u32 s[48:49], s30, v110
  v_cmp_le_u32 vcc, s30, v111
  v_cndmask_b32_e64 v97, v97, v106, s[44:45]
  v_cndmask_b32_e64 v99, v99, v106, s[46:47]
  v_cndmask_b32_e64 v101, v101, v106, s[48:49]
  v_cndmask_b32 v103, v103, v106, vcc
  v_sub_u32 v108, v108, v97
  v_cmp_lt_u32 vcc, 1, v108
s_nop 1
  v_cndmask_b32_e64 v105, 2, 4, vcc
  v_add_u32 v108, v108, v105
  v_lshlrev_b32 v97, 5, v108
  v_sub_u32 v109, v109, v99
  v_cmp_lt_u32 vcc, 1, v109
s_nop 1
  v_cndmask_b32_e64 v105, 2, 4, vcc
  v_add_u32 v109, v109, v105
  v_lshlrev_b32 v99, 5, v109
  v_sub_u32 v110, v110, v101
  v_cmp_lt_u32 vcc, 1, v110
s_nop 1
  v_cndmask_b32_e64 v105, 2, 4, vcc
  v_add_u32 v110, v110, v105
  v_lshlrev_b32 v101, 5, v110
  v_sub_u32 v111, v111, v103
  v_cmp_lt_u32 vcc, 1, v111
s_nop 1
  v_cndmask_b32_e64 v105, 2, 4, vcc
  v_add_u32 v111, v111, v105
  v_lshlrev_b32 v103, 5, v111
  v_lshlrev_b32 v104, 5, v80
  ds_write_b128 v104, v[96:99] offset:4384
  ds_write_b128 v104, v[100:103] offset:4400
  v_and_b32 v96, 0x3fc, v145
  v_lshlrev_b32 v96, 1, v96
  ds_read_b64 v[96:97], v96 offset:4384
  v_and_b32 v98, 0x3fc, v149
  v_lshlrev_b32 v98, 1, v98
  ds_read_b64 v[98:99], v98 offset:4384
  v_and_b32 v100, 0x3fc, v153
  v_lshlrev_b32 v100, 1, v100
  ds_read_b64 v[100:101], v100 offset:4384
  v_and_b32 v102, 0x3fc, v157
  v_lshlrev_b32 v102, 1, v102
  ds_read_b64 v[102:103], v102 offset:4384
  v_and_b32 v104, 0x3fc, v161
  v_lshlrev_b32 v104, 1, v104
  ds_read_b64 v[104:105], v104 offset:4384
  v_and_b32 v106, 0x3fc, v165
  v_lshlrev_b32 v106, 1, v106
  ds_read_b64 v[106:107], v106 offset:4384
  v_and_b32 v108, 0x3fc, v169
  v_lshlrev_b32 v108, 1, v108
  ds_read_b64 v[108:109], v108 offset:4384
  v_and_b32 v110, 0x3fc, v173
  v_lshlrev_b32 v110, 1, v110
  ds_read_b64 v[110:111], v110 offset:4384
  v_and_b32 v208, 0x3fc, v177
  v_lshlrev_b32 v208, 1, v208
  ds_read_b64 v[208:209], v208 offset:4384
  v_and_b32 v210, 0x3fc, v181
  v_lshlrev_b32 v210, 1, v210
  ds_read_b64 v[210:211], v210 offset:4384
  v_and_b32 v212, 0x3fc, v185
  v_lshlrev_b32 v212, 1, v212
  ds_read_b64 v[212:213], v212 offset:4384
  v_and_b32 v214, 0x3fc, v189
  v_lshlrev_b32 v214, 1, v214
  ds_read_b64 v[214:215], v214 offset:4384
  v_and_b32 v216, 0x3fc, v193
  v_lshlrev_b32 v216, 1, v216
  ds_read_b64 v[216:217], v216 offset:4384
  v_and_b32 v218, 0x3fc, v197
  v_lshlrev_b32 v218, 1, v218
  ds_read_b64 v[218:219], v218 offset:4384
  v_and_b32 v220, 0x3fc, v201
  v_lshlrev_b32 v220, 1, v220
  ds_read_b64 v[220:221], v220 offset:4384
  v_and_b32 v222, 0x3fc, v205
  v_lshlrev_b32 v222, 1, v222
  ds_read_b64 v[222:223], v222 offset:4384
  s_waitcnt lgkmcnt(15)
  v_add_u32 v96, v96, v224
  v_lshlrev_b32 v96, 4, v96
  v_and_or_b32 v145, v145, s23, v97
  v_mov_b32 v147, v97
  s_mov_b64 exec, s[64:65]
  ds_write_b128 v96, v[144:147] offset:8192
  s_mov_b64 exec, -1
  s_waitcnt lgkmcnt(15)
  v_add_u32 v98, v98, v225
  v_lshlrev_b32 v98, 4, v98
  v_and_or_b32 v149, v149, s23, v99
  v_mov_b32 v151, v99
  s_mov_b64 exec, s[66:67]
  ds_write_b128 v98, v[148:151] offset:8192
  s_mov_b64 exec, -1
  s_waitcnt lgkmcnt(15)
  v_add_u32 v100, v100, v226
  v_lshlrev_b32 v100, 4, v100
  v_and_or_b32 v153, v153, s23, v101
  v_mov_b32 v155, v101
  s_mov_b64 exec, s[68:69]
  ds_write_b128 v100, v[152:155] offset:8192
  s_mov_b64 exec, -1
  s_waitcnt lgkmcnt(15)
  v_add_u32 v102, v102, v227
  v_lshlrev_b32 v102, 4, v102
  v_and_or_b32 v157, v157, s23, v103
  v_mov_b32 v159, v103
  s_mov_b64 exec, s[70:71]
  ds_write_b128 v102, v[156:159] offset:8192
  s_mov_b64 exec, -1
  s_waitcnt lgkmcnt(15)
  v_add_u32 v104, v104, v228
  v_lshlrev_b32 v104, 4, v104
  v_and_or_b32 v161, v161, s23, v105
  v_mov_b32 v163, v105
  s_mov_b64 exec, s[72:73]
  ds_write_b128 v104, v[160:163] offset:8192
  s_mov_b64 exec, -1
  s_waitcnt lgkmcnt(15)
  v_add_u32 v106, v106, v229
  v_lshlrev_b32 v106, 4, v106
  v_and_or_b32 v165, v165, s23, v107
  v_mov_b32 v167, v107
  s_mov_b64 exec, s[74:75]
  ds_write_b128 v106, v[164:167] offset:8192
  s_mov_b64 exec, -1
  s_waitcnt lgkmcnt(15)
  v_add_u32 v108, v108, v230
  v_lshlrev_b32 v108, 4, v108
  v_and_or_b32 v169, v169, s23, v109
  v_mov_b32 v171, v109
  s_mov_b64 exec, s[76:77]
  ds_write_b128 v108, v[168:171] offset:8192
  s_mov_b64 exec, -1
  s_waitcnt lgkmcnt(15)
  v_add_u32 v110, v110, v231
  v_lshlrev_b32 v110, 4, v110
  v_and_or_b32 v173, v173, s23, v111
  v_mov_b32 v175, v111
  s_mov_b64 exec, s[78:79]
  ds_write_b128 v110, v[172:175] offset:8192
  s_mov_b64 exec, -1
  s_waitcnt lgkmcnt(15)
  v_add_u32 v208, v208, v248
  v_lshlrev_b32 v208, 4, v208
  v_and_or_b32 v177, v177, s23, v209
  v_mov_b32 v179, v209
  s_mov_b64 exec, s[80:81]
  ds_write_b128 v208, v[176:179] offset:8192
  s_mov_b64 exec, -1
  s_waitcnt lgkmcnt(15)
  v_add_u32 v210, v210, v249
  v_lshlrev_b32 v210, 4, v210
  v_and_or_b32 v181, v181, s23, v211
  v_mov_b32 v183, v211
  s_mov_b64 exec, s[82:83]
  ds_write_b128 v210, v[180:183] offset:8192
  s_mov_b64 exec, -1
  s_waitcnt lgkmcnt(15)
  v_add_u32 v212, v212, v250
  v_lshlrev_b32 v212, 4, v212
  v_and_or_b32 v185, v185, s23, v213
  v_mov_b32 v187, v213
  s_mov_b64 exec, s[84:85]
  ds_write_b128 v212, v[184:187] offset:8192
  s_mov_b64 exec, -1
  s_waitcnt lgkmcnt(15)
  v_add_u32 v214, v214, v251
  v_lshlrev_b32 v214, 4, v214
  v_and_or_b32 v189, v189, s23, v215
  v_mov_b32 v191, v215
  s_mov_b64 exec, s[86:87]
  ds_write_b128 v214, v[188:191] offset:8192
  s_mov_b64 exec, -1
  s_waitcnt lgkmcnt(15)
  v_add_u32 v216, v216, v252
  v_lshlrev_b32 v216, 4, v216
  v_and_or_b32 v193, v193, s23, v217
  v_mov_b32 v195, v217
  s_mov_b64 exec, s[88:89]
  ds_write_b128 v216, v[192:195] offset:8192
  s_mov_b64 exec, -1
  s_waitcnt lgkmcnt(15)
  v_add_u32 v218, v218, v253
  v_lshlrev_b32 v218, 4, v218
  v_and_or_b32 v197, v197, s23, v219
  v_mov_b32 v199, v219
  s_mov_b64 exec, s[90:91]
  ds_write_b128 v218, v[196:199] offset:8192
  s_mov_b64 exec, -1
  s_waitcnt lgkmcnt(15)
  v_add_u32 v220, v220, v254
  v_lshlrev_b32 v220, 4, v220
  v_and_or_b32 v201, v201, s23, v221
  v_mov_b32 v203, v221
  s_mov_b64 exec, s[92:93]
  ds_write_b128 v220, v[200:203] offset:8192
  s_mov_b64 exec, -1
  s_waitcnt lgkmcnt(15)
  v_add_u32 v222, v222, v255
  v_lshlrev_b32 v222, 4, v222
  v_and_or_b32 v205, v205, s23, v223
  v_mov_b32 v207, v223
  s_mov_b64 exec, s[94:95]
  ds_write_b128 v222, v[204:207] offset:8192
  s_mov_b64 exec, -1
  v_add_u32 v86, s31, v95
  v_lshlrev_b32 v86, 4, v86
  v_mov_b32 v216, 0
  v_mov_b32 v217, 0
  v_mov_b32 v218, 0
  v_mov_b32 v219, 0
  v_cmp_gt_u32 vcc, 64, v95
s_nop 0
  s_and_saveexec_b64 s[44:45], vcc
  ds_write_b128 v86, v[216:219] offset:8192
  s_mov_b64 exec, s[44:45]
  s_lshl_b32 s32, s34, 2
  s_add_u32 s33, s34, s35
  s_lshl_b32 s33, s33, 2
  v_mov_b32 v86, s32
  v_mov_b32 v89, s33
  ds_read_b32 v87, v86 offset:3328
  ds_read_b32 v88, v89 offset:3328
  v_lshl_add_u32 v89, v85, 2, s32
  v_max_i32 v89, v89, v86
  v_add_u32 v89, 3328, v89
  ds_read2_b32 v[90:91], v89 offset0:0 offset1:1
  s_waitcnt lgkmcnt(2)
  v_readfirstlane_b32 s32, v87
  s_waitcnt lgkmcnt(1)
  v_readfirstlane_b32 s33, v88
s_nop 0
  s_sub_u32 s25, s33, s32
  s_add_u32 s25, s25, 31
  s_lshr_b32 s25, s25, 5
  s_min_u32 s25, s25, 128
  v_lshrrev_b32 v86, v81, s36
  v_and_b32 v86, 1, v86
  v_cmp_eq_u32 vcc, 1, v86
  v_mov_b32 v87, s32
  s_waitcnt lgkmcnt(0)
s_nop 0
  v_cndmask_b32 v90, v87, v90, vcc
  v_cndmask_b32 v91, v87, v91, vcc
  v_lshl_add_u32 v87, v82, 2, s32
  v_sub_u32 v236, v90, v87
  v_sub_u32 v237, v91, v87
  v_lshrrev_b32 v86, 3, v80
  v_add_u32 v86, s32, v86
  v_lshlrev_b32 v86, 4, v86
  v_add_u32 v234, 8198, v86
  v_add_u32 v86, s32, v81
  v_lshlrev_b32 v86, 4, v86
  v_lshl_add_u32 v86, v82, 3, v86
  v_add_u32 v235, 8192, v86
  s_waitcnt lgkmcnt(0)
  s_barrier
  s_mov_b32 s38, 0
  s_mov_b32 s26, 0
  ds_read_u16 v240, v234 offset:0
  ds_read_u16 v241, v234 offset:128
  ds_read_u16 v242, v234 offset:256
  ds_read_u16 v243, v234 offset:384
  s_add_u32 s29, s26, 0
  s_cmp_lt_u32 s29, s25
  s_cselect_b32 s28, 0, 0x80000000
  s_waitcnt lgkmcnt(3)
  v_lshl_add_u32 v240, v240, 7, v232
  s_waitcnt lgkmcnt(2)
  v_lshl_add_u32 v241, v241, 7, v232
  s_waitcnt lgkmcnt(1)
  v_lshl_add_u32 v242, v242, 7, v232
  s_waitcnt lgkmcnt(0)
  v_lshl_add_u32 v243, v243, 7, v232
  s_add_u32 m0, s27, 0
s_nop 0
  buffer_load_dwordx4 v240, s[8:11], s28 offen lds
  s_add_u32 m0, s27, 1056
s_nop 0
  buffer_load_dwordx4 v241, s[8:11], s28 offen lds
  s_add_u32 m0, s27, 2112
s_nop 0
  buffer_load_dwordx4 v242, s[8:11], s28 offen lds
  s_add_u32 m0, s27, 3168
s_nop 0
  buffer_load_dwordx4 v243, s[8:11], s28 offen lds
  v_mov_b32 v144, 0
  v_mov_b32 v176, 0
  v_mov_b32 v145, 0
  v_mov_b32 v177, 0
  v_mov_b32 v146, 0
  v_mov_b32 v178, 0
  v_mov_b32 v147, 0
  v_mov_b32 v179, 0
  v_mov_b32 v148, 0
  v_mov_b32 v180, 0
  v_mov_b32 v149, 0
  v_mov_b32 v181, 0
  v_mov_b32 v150, 0
  v_mov_b32 v182, 0
  v_mov_b32 v151, 0
  v_mov_b32 v183, 0
  v_mov_b32 v152, 0
  v_mov_b32 v184, 0
  v_mov_b32 v153, 0
  v_mov_b32 v185, 0
  v_mov_b32 v154, 0
  v_mov_b32 v186, 0
  v_mov_b32 v155, 0
  v_mov_b32 v187, 0
  v_mov_b32 v156, 0
  v_mov_b32 v188, 0
  v_mov_b32 v157, 0
  v_mov_b32 v189, 0
  v_mov_b32 v158, 0
  v_mov_b32 v190, 0
  v_mov_b32 v159, 0
  v_mov_b32 v191, 0
  v_mov_b32 v160, 0
  v_mov_b32 v192, 0
  v_mov_b32 v161, 0
  v_mov_b32 v193, 0
  v_mov_b32 v162, 0
  v_mov_b32 v194, 0
  v_mov_b32 v163, 0
  v_mov_b32 v195, 0
  v_mov_b32 v164, 0
  v_mov_b32 v196, 0
  v_mov_b32 v165, 0
  v_mov_b32 v197, 0
  v_mov_b32 v166, 0
  v_mov_b32 v198, 0
  v_mov_b32 v167, 0
  v_mov_b32 v199, 0
  v_mov_b32 v168, 0
  v_mov_b32 v200, 0
  v_mov_b32 v169, 0
  v_mov_b32 v201, 0
  v_mov_b32 v170, 0
  v_mov_b32 v202, 0
  v_mov_b32 v171, 0
  v_mov_b32 v203, 0
  v_mov_b32 v172, 0
  v_mov_b32 v204, 0
  v_mov_b32 v173, 0
  v_mov_b32 v205, 0
  v_mov_b32 v174, 0
  v_mov_b32 v206, 0
  v_mov_b32 v175, 0
  v_mov_b32 v207, 0
  s_waitcnt vmcnt(4)
  ds_read_b128 v[208:211], v233 offset:4224
  ds_read_b128 v[212:215], v233 offset:4256
  ds_read_b128 v[216:219], v233 offset:4288
  ds_read_b128 v[220:223], v233 offset:4320
  s_waitcnt lgkmcnt(3)
  v_mfma_f32_32x32x16_bf16 v[80:95], v[208:211], v[112:115], 0
  s_waitcnt lgkmcnt(2)
  v_mfma_f32_32x32x16_bf16 v[80:95], v[212:215], v[120:123], v[80:95]
  s_waitcnt lgkmcnt(1)
  v_mfma_f32_32x32x16_bf16 v[80:95], v[216:219], v[128:131], v[80:95]
  s_waitcnt lgkmcnt(0)
  v_mfma_f32_32x32x16_bf16 v[80:95], v[220:223], v[136:139], v[80:95]
  v_mfma_f32_32x32x16_bf16 v[96:111], v[208:211], v[116:119], 0
  v_mfma_f32_32x32x16_bf16 v[96:111], v[212:215], v[124:127], v[96:111]
  v_mfma_f32_32x32x16_bf16 v[96:111], v[216:219], v[132:135], v[96:111]
  v_mfma_f32_32x32x16_bf16 v[96:111], v[220:223], v[140:143], v[96:111]
s_nop 7
  v_cvt_pk_bf16_f32 v65, v82, v83
  v_cvt_pk_bf16_f32 v66, v84, v85
  v_cvt_pk_bf16_f32 v67, v86, v87
  v_cvt_pk_bf16_f32 v72, v88, v89
  v_cvt_pk_bf16_f32 v73, v90, v91
  v_cvt_pk_bf16_f32 v74, v92, v93
  v_cvt_pk_bf16_f32 v75, v94, v95
  v_cvt_pk_bf16_f32 v69, v98, v99
  v_cvt_pk_bf16_f32 v70, v100, v101
  v_cvt_pk_bf16_f32 v71, v102, v103
  v_cvt_pk_bf16_f32 v76, v104, v105
  v_cvt_pk_bf16_f32 v77, v106, v107
  v_cvt_pk_bf16_f32 v78, v108, v109
  v_cvt_pk_bf16_f32 v79, v110, v111
  ds_read_u16 v240, v234 offset:512
  ds_read_u16 v241, v234 offset:640
  ds_read_u16 v242, v234 offset:768
  ds_read_u16 v243, v234 offset:896
  s_add_u32 s29, s26, 1
  s_cmp_lt_u32 s29, s25
  s_cselect_b32 s28, 0, 0x80000000
  s_waitcnt lgkmcnt(3)
  v_lshl_add_u32 v240, v240, 7, v232
  s_waitcnt lgkmcnt(2)
  v_lshl_add_u32 v241, v241, 7, v232
  s_waitcnt lgkmcnt(1)
  v_lshl_add_u32 v242, v242, 7, v232
  s_waitcnt lgkmcnt(0)
  v_lshl_add_u32 v243, v243, 7, v232
  s_add_u32 m0, s27, 4224
s_nop 0
  buffer_load_dwordx4 v240, s[8:11], s28 offen lds
  s_add_u32 m0, s27, 5280
s_nop 0
  buffer_load_dwordx4 v241, s[8:11], s28 offen lds
  s_add_u32 m0, s27, 6336
s_nop 0
  buffer_load_dwordx4 v242, s[8:11], s28 offen lds
  s_add_u32 m0, s27, 7392
s_nop 0
  buffer_load_dwordx4 v243, s[8:11], s28 offen lds
  ds_read_b64 v[224:225], v235 offset:0
  s_waitcnt vmcnt(4)
  ds_read_b128 v[208:211], v233 offset:0
  ds_read_b128 v[212:215], v233 offset:32
  ds_read_b128 v[216:219], v233 offset:64
  ds_read_b128 v[220:223], v233 offset:96
  ds_read_u16 v240, v234 offset:1024
  ds_read_u16 v241, v234 offset:1152
  ds_read_u16 v242, v234 offset:1280
  ds_read_u16 v243, v234 offset:1408
  s_waitcnt lgkmcnt(8)
  v_and_or_b32 v239, v225, s21, v238
  ds_read_b32 v225, v239 offset:4
  ds_read_b64 v[226:227], v239 offset:8
  ds_read_b128 v[228:231], v239 offset:16
  s_add_u32 s29, s26, 2
  s_cmp_lt_u32 s29, s25
  s_cselect_b32 s28, 0, 0x80000000
  s_waitcnt lgkmcnt(6)
  v_lshl_add_u32 v240, v240, 7, v232
  s_waitcnt lgkmcnt(5)
  v_lshl_add_u32 v241, v241, 7, v232
  s_waitcnt lgkmcnt(4)
  v_lshl_add_u32 v242, v242, 7, v232
  s_waitcnt lgkmcnt(3)
  v_lshl_add_u32 v243, v243, 7, v232
  s_add_u32 m0, s27, 0
s_nop 0
  buffer_load_dwordx4 v240, s[8:11], s28 offen lds
  s_add_u32 m0, s27, 1056
s_nop 0
  buffer_load_dwordx4 v241, s[8:11], s28 offen lds
  s_add_u32 m0, s27, 2112
s_nop 0
  buffer_load_dwordx4 v242, s[8:11], s28 offen lds
  s_add_u32 m0, s27, 3168
s_nop 0
  buffer_load_dwordx4 v243, s[8:11], s28 offen lds
  v_mfma_f32_32x32x16_bf16 v[80:95], v[208:211], v[0:3], 0
  v_mfma_f32_32x32x16_bf16 v[80:95], v[212:215], v[8:11], v[80:95]
  v_mfma_f32_32x32x16_bf16 v[80:95], v[216:219], v[16:19], v[80:95]
  v_mfma_f32_32x32x16_bf16 v[80:95], v[220:223], v[24:27], v[80:95]
  s_waitcnt lgkmcnt(1)
  v_mfma_f32_32x32x16_bf16 v[80:95], v[224:227], v[64:67], v[80:95]
  s_waitcnt lgkmcnt(0)
  v_mfma_f32_32x32x16_bf16 v[80:95], v[228:231], v[72:75], v[80:95]
  v_mfma_f32_32x32x16_bf16 v[112:127], v[208:211], v[32:35], 0
  v_mfma_f32_32x32x16_bf16 v[112:127], v[212:215], v[40:43], v[112:127]
  v_mfma_f32_32x32x16_bf16 v[112:127], v[216:219], v[48:51], v[112:127]
  v_mfma_f32_32x32x16_bf16 v[112:127], v[220:223], v[56:59], v[112:127]
  s_branch K3_SORTED
K3_SLOW:
  s_waitcnt vmcnt(0)
  s_mul_i32 s34, s3, 25
  s_mov_b32 s35, 25
  s_mov_b32 s36, 0x1fffffcc
  s_mul_i32 s32, s2, 200
  s_add_u32 s32, s32, s34
  v_lshrrev_b32 v86, 3, v80
  v_mov_b32 v89, 0x80000000
  v_add_u32 v87, 0, v86
  v_subrev_u32 v88, 2, v87
  v_subrev_u32 v90, 4, v87
  v_cmp_gt_u32 vcc, 4, v87
s_nop 1
  v_cndmask_b32 v88, v90, v88, vcc
  v_add_u32 v88, s32, v88
  v_lshl_add_u32 v240, v88, 7, v232
  v_lshrrev_b32 v88, v87, s36
  v_and_b32 v88, 1, v88
  v_cmp_eq_u32 vcc, 1, v88
s_nop 1
  v_cndmask_b32 v240, v89, v240, vcc
  v_add_u32 v87, 8, v86
  v_subrev_u32 v88, 4, v87
  v_add_u32 v88, s32, v88
  v_lshl_add_u32 v241, v88, 7, v232
  v_lshrrev_b32 v88, v87, s36
  v_and_b32 v88, 1, v88
  v_cmp_eq_u32 vcc, 1, v88
s_nop 1
  v_cndmask_b32 v241, v89, v241, vcc
  v_add_u32 v87, 16, v86
  v_subrev_u32 v88, 4, v87
  v_add_u32 v88, s32, v88
  v_lshl_add_u32 v242, v88, 7, v232
  v_lshrrev_b32 v88, v87, s36
  v_and_b32 v88, 1, v88
  v_cmp_eq_u32 vcc, 1, v88
s_nop 1
  v_cndmask_b32 v242, v89, v242, vcc
  v_add_u32 v87, 24, v86
  v_subrev_u32 v88, 4, v87
  v_add_u32 v88, s32, v88
  v_lshl_add_u32 v243, v88, 7, v232
  v_lshrrev_b32 v88, v87, s36
  v_and_b32 v88, 1, v88
  v_cmp_eq_u32 vcc, 1, v88
s_nop 1
  v_cndmask_b32 v243, v89, v243, vcc
  s_add_u32 m0, s27, 0
s_nop 0
  buffer_load_dwordx4 v240, s[8:11], 0 offen lds
  s_add_u32 m0, s27, 1056
s_nop 0
  buffer_load_dwordx4 v241, s[8:11], 0 offen lds
  s_add_u32 m0, s27, 2112
s_nop 0
  buffer_load_dwordx4 v242, s[8:11], 0 offen lds
  s_add_u32 m0, s27, 3168
s_nop 0
  buffer_load_dwordx4 v243, s[8:11], 0 offen lds
  s_waitcnt vmcnt(0)
  ds_read_b128 v[208:211], v233 offset:0
  ds_read_b128 v[212:215], v233 offset:32
  ds_read_b128 v[216:219], v233 offset:64
  ds_read_b128 v[220:223], v233 offset:96
  s_waitcnt lgkmcnt(3)
  v_mfma_f32_32x32x16_bf16 v[80:95], v[208:211], v[112:115], 0
  s_waitcnt lgkmcnt(2)
  v_mfma_f32_32x32x16_bf16 v[80:95], v[212:215], v[120:123], v[80:95]
  s_waitcnt lgkmcnt(1)
  v_mfma_f32_32x32x16_bf16 v[80:95], v[216:219], v[128:131], v[80:95]
  s_waitcnt lgkmcnt(0)
  v_mfma_f32_32x32x16_bf16 v[80:95], v[220:223], v[136:139], v[80:95]
  v_mfma_f32_32x32x16_bf16 v[96:111], v[208:211], v[116:119], 0
  v_mfma_f32_32x32x16_bf16 v[96:111], v[212:215], v[124:127], v[96:111]
  v_mfma_f32_32x32x16_bf16 v[96:111], v[216:219], v[132:135], v[96:111]
  v_mfma_f32_32x32x16_bf16 v[96:111], v[220:223], v[140:143], v[96:111]
s_nop 7
  v_cvt_pk_bf16_f32 v65, v82, v83
  v_cvt_pk_bf16_f32 v66, v84, v85
  v_cvt_pk_bf16_f32 v67, v86, v87
  v_cvt_pk_bf16_f32 v72, v88, v89
  v_cvt_pk_bf16_f32 v73, v90, v91
  v_cvt_pk_bf16_f32 v74, v92, v93
  v_cvt_pk_bf16_f32 v75, v94, v95
  v_cvt_pk_bf16_f32 v69, v98, v99
  v_cvt_pk_bf16_f32 v70, v100, v101
  v_cvt_pk_bf16_f32 v71, v102, v103
  v_cvt_pk_bf16_f32 v76, v104, v105
  v_cvt_pk_bf16_f32 v77, v106, v107
  v_cvt_pk_bf16_f32 v78, v108, v109
  v_cvt_pk_bf16_f32 v79, v110, v111
  v_mbcnt_lo_u32_b32 v80, -1, 0
  v_mbcnt_hi_u32_b32 v80, -1, v80
  v_mov_b32 v95, s3
  v_lshl_add_u32 v95, v95, 6, v80
  v_and_b32 v81, 31, v80
  v_lshrrev_b32 v82, 5, v80
  v_subrev_u32 v85, 4, v81
  v_subrev_u32 v86, 2, v81
  v_cmp_gt_u32 vcc, 4, v81
s_nop 1
  v_cndmask_b32 v85, v85, v86, vcc
  v_mov_b32 v144, 0
  v_mov_b32 v176, 0
  v_mov_b32 v145, 0
  v_mov_b32 v177, 0
  v_mov_b32 v146, 0
  v_mov_b32 v178, 0
  v_mov_b32 v147, 0
  v_mov_b32 v179, 0
  v_mov_b32 v148, 0
  v_mov_b32 v180, 0
  v_mov_b32 v149, 0
  v_mov_b32 v181, 0
  v_mov_b32 v150, 0
  v_mov_b32 v182, 0
  v_mov_b32 v151, 0
  v_mov_b32 v183, 0
  v_mov_b32 v152, 0
  v_mov_b32 v184, 0
  v_mov_b32 v153, 0
  v_mov_b32 v185, 0
  v_mov_b32 v154, 0
  v_mov_b32 v186, 0
  v_mov_b32 v155, 0
  v_mov_b32 v187, 0
  v_mov_b32 v156, 0
  v_mov_b32 v188, 0
  v_mov_b32 v157, 0
  v_mov_b32 v189, 0
  v_mov_b32 v158, 0
  v_mov_b32 v190, 0
  v_mov_b32 v159, 0
  v_mov_b32 v191, 0
  v_mov_b32 v160, 0
  v_mov_b32 v192, 0
  v_mov_b32 v161, 0
  v_mov_b32 v193, 0
  v_mov_b32 v162, 0
  v_mov_b32 v194, 0
  v_mov_b32 v163, 0
  v_mov_b32 v195, 0
  v_mov_b32 v164, 0
  v_mov_b32 v196, 0
  v_mov_b32 v165, 0
  v_mov_b32 v197, 0
  v_mov_b32 v166, 0
  v_mov_b32 v198, 0
  v_mov_b32 v167, 0
  v_mov_b32 v199, 0
  v_mov_b32 v168, 0
  v_mov_b32 v200, 0
  v_mov_b32 v169, 0
  v_mov_b32 v201, 0
  v_mov_b32 v170, 0
  v_mov_b32 v202, 0
  v_mov_b32 v171, 0
  v_mov_b32 v203, 0
  v_mov_b32 v172, 0
  v_mov_b32 v204, 0
  v_mov_b32 v173, 0
  v_mov_b32 v205, 0
  v_mov_b32 v174, 0
  v_mov_b32 v206, 0
  v_mov_b32 v175, 0
  v_mov_b32 v207, 0
  s_mul_i32 s32, s2, 1024
  s_add_u32 s32, s32, 12800000
  s_mov_b32 s40, s6
  s_mov_b32 s41, s7
  s_mov_b32 s42, 0
  s_mov_b32 s43, 0x00020000
  s_add_u32 s42, s32, 1000
  v_lshlrev_b32 v86, 4, v80
  buffer_load_dwordx4 v[208:211], v86, s[40:43], s32 offen
  s_waitcnt vmcnt(0)
  v_lshrrev_b32 v212, 16, v208
  v_lshrrev_b32 v213, 16, v209
  v_lshrrev_b32 v214, 16, v210
  v_lshrrev_b32 v215, 16, v211
  v_add_u32 v221, v212, v213
  v_add_u32 v222, v221, v214
  v_add_u32 v223, v222, v215
  v_mov_b32 v220, v223
s_nop 1
  v_add_u32_dpp v220, v220, v220 row_shr:1 row_mask:0xf bank_mask:0xf
s_nop 1
  v_add_u32_dpp v220, v220, v220 row_shr:2 row_mask:0xf bank_mask:0xf
s_nop 1
  v_add_u32_dpp v220, v220, v220 row_shr:4 row_mask:0xf bank_mask:0xf
s_nop 1
  v_add_u32_dpp v220, v220, v220 row_shr:8 row_mask:0xf bank_mask:0xf
s_nop 1
  v_add_u32_dpp v220, v220, v220 row_bcast:15 row_mask:0xa bank_mask:0xf
s_nop 1
  v_add_u32_dpp v220, v220, v220 row_bcast:31 row_mask:0xc bank_mask:0xf
  v_sub_u32 v216, v220, v223
  v_add_u32 v217, v216, v212
  v_add_u32 v218, v216, v221
  v_add_u32 v219, v216, v222
  ds_write_b128 v86, v[216:219] offset:4384
  v_mul_u32_u24 v87, 12800, v80
  v_and_b32 v208, 0xffff, v208
  v_add_u32 v208, v208, v87
  v_sub_u32 v208, v208, v216
  v_and_b32 v209, 0xffff, v209
  v_add_u32 v209, v209, v87
  v_add_u32 v209, 3200, v209
  v_sub_u32 v209, v209, v217
  v_and_b32 v210, 0xffff, v210
  v_add_u32 v210, v210, v87
  v_add_u32 v210, 6400, v210
  v_sub_u32 v210, v210, v218
  v_and_b32 v211, 0xffff, v211
  v_add_u32 v211, v211, v87
  v_add_u32 v211, 9600, v211
  v_sub_u32 v211, v211, v219
  ds_write_b128 v86, v[208:211] offset:5424
  v_readlane_b32 s31, v220, 63
  s_mov_b32 s38, 0
K3_BATCH:
  s_waitcnt lgkmcnt(0)
  s_barrier
  v_mbcnt_lo_u32_b32 v80, -1, 0
  v_mbcnt_hi_u32_b32 v80, -1, v80
  v_mov_b32 v95, s3
  v_lshl_add_u32 v95, v95, 6, v80
  v_and_b32 v81, 31, v80
  v_lshrrev_b32 v82, 5, v80
  v_subrev_u32 v85, 4, v81
  v_subrev_u32 v86, 2, v81
  v_cmp_gt_u32 vcc, 4, v81
s_nop 1
  v_cndmask_b32 v85, v85, v86, vcc
  s_sub_u32 s39, s31, s38
  s_min_u32 s39, s39, 3584
  s_add_u32 s39, s39, s38
  s_sub_u32 s32, s39, 1
  v_add_u32 v124, s38, v95
  v_mov_b32 v131, 0
  v_add_u32 v125, s38, v95
  v_add_u32 v125, 512, v125
  v_mov_b32 v132, 0
  v_add_u32 v126, s38, v95
  v_add_u32 v126, 1024, v126
  v_mov_b32 v133, 0
  v_add_u32 v127, s38, v95
  v_add_u32 v127, 1536, v127
  v_mov_b32 v134, 0
  v_add_u32 v128, s38, v95
  v_add_u32 v128, 2048, v128
  v_mov_b32 v135, 0
  v_add_u32 v129, s38, v95
  v_add_u32 v129, 2560, v129
  v_mov_b32 v136, 0
  v_add_u32 v130, s38, v95
  v_add_u32 v130, 3072, v130
  v_mov_b32 v137, 0
  ds_read_b32 v208, v131 offset:4896
  ds_read_b32 v209, v132 offset:4896
  ds_read_b32 v210, v133 offset:4896
  ds_read_b32 v211, v134 offset:4896
  ds_read_b32 v212, v135 offset:4896
  ds_read_b32 v213, v136 offset:4896
  ds_read_b32 v214, v137 offset:4896
  s_mov_b32 s33, 512
  s_waitcnt lgkmcnt(6)
  v_sub_u32 v216, v124, v208
  v_ashrrev_i32 v216, 31, v216
  v_bfi_b32 v216, v216, 0, s33
  v_add_u32 v131, v131, v216
  s_waitcnt lgkmcnt(5)
  v_sub_u32 v217, v125, v209
  v_ashrrev_i32 v217, 31, v217
  v_bfi_b32 v217, v217, 0, s33
  v_add_u32 v132, v132, v217
  s_waitcnt lgkmcnt(4)
  v_sub_u32 v218, v126, v210
  v_ashrrev_i32 v218, 31, v218
  v_bfi_b32 v218, v218, 0, s33
  v_add_u32 v133, v133, v218
  s_waitcnt lgkmcnt(3)
  v_sub_u32 v219, v127, v211
  v_ashrrev_i32 v219, 31, v219
  v_bfi_b32 v219, v219, 0, s33
  v_add_u32 v134, v134, v219
  s_waitcnt lgkmcnt(2)
  v_sub_u32 v220, v128, v212
  v_ashrrev_i32 v220, 31, v220
  v_bfi_b32 v220, v220, 0, s33
  v_add_u32 v135, v135, v220
  s_waitcnt lgkmcnt(1)
  v_sub_u32 v221, v129, v213
  v_ashrrev_i32 v221, 31, v221
  v_bfi_b32 v221, v221, 0, s33
  v_add_u32 v136, v136, v221
  s_waitcnt lgkmcnt(0)
  v_sub_u32 v222, v130, v214
  v_ashrrev_i32 v222, 31, v222
  v_bfi_b32 v222, v222, 0, s33
  v_add_u32 v137, v137, v222
  ds_read_b32 v208, v131 offset:4640
  ds_read_b32 v209, v132 offset:4640
  ds_read_b32 v210, v133 offset:4640
  ds_read_b32 v211, v134 offset:4640
  ds_read_b32 v212, v135 offset:4640
  ds_read_b32 v213, v136 offset:4640
  ds_read_b32 v214, v137 offset:4640
  s_mov_b32 s33, 256
  s_waitcnt lgkmcnt(6)
  v_sub_u32 v216, v124, v208
  v_ashrrev_i32 v216, 31, v216
  v_bfi_b32 v216, v216, 0, s33
  v_add_u32 v131, v131, v216
  s_waitcnt lgkmcnt(5)
  v_sub_u32 v217, v125, v209
  v_ashrrev_i32 v217, 31, v217
  v_bfi_b32 v217, v217, 0, s33
  v_add_u32 v132, v132, v217
  s_waitcnt lgkmcnt(4)
  v_sub_u32 v218, v126, v210
  v_ashrrev_i32 v218, 31, v218
  v_bfi_b32 v218, v218, 0, s33
  v_add_u32 v133, v133, v218
  s_waitcnt lgkmcnt(3)
  v_sub_u32 v219, v127, v211
  v_ashrrev_i32 v219, 31, v219
  v_bfi_b32 v219, v219, 0, s33
  v_add_u32 v134, v134, v219
  s_waitcnt lgkmcnt(2)
  v_sub_u32 v220, v128, v212
  v_ashrrev_i32 v220, 31, v220
  v_bfi_b32 v220, v220, 0, s33
  v_add_u32 v135, v135, v220
  s_waitcnt lgkmcnt(1)
  v_sub_u32 v221, v129, v213
  v_ashrrev_i32 v221, 31, v221
  v_bfi_b32 v221, v221, 0, s33
  v_add_u32 v136, v136, v221
  s_waitcnt lgkmcnt(0)
  v_sub_u32 v222, v130, v214
  v_ashrrev_i32 v222, 31, v222
  v_bfi_b32 v222, v222, 0, s33
  v_add_u32 v137, v137, v222
  ds_read_b32 v208, v131 offset:4512
  ds_read_b32 v209, v132 offset:4512
  ds_read_b32 v210, v133 offset:4512
  ds_read_b32 v211, v134 offset:4512
  ds_read_b32 v212, v135 offset:4512
  ds_read_b32 v213, v136 offset:4512
  ds_read_b32 v214, v137 offset:4512
  s_mov_b32 s33, 128
  s_waitcnt lgkmcnt(6)
  v_sub_u32 v216, v124, v208
  v_ashrrev_i32 v216, 31, v216
  v_bfi_b32 v216, v216, 0, s33
  v_add_u32 v131, v131, v216
  s_waitcnt lgkmcnt(5)
  v_sub_u32 v217, v125, v209
  v_ashrrev_i32 v217, 31, v217
  v_bfi_b32 v217, v217, 0, s33
  v_add_u32 v132, v132, v217
  s_waitcnt lgkmcnt(4)
  v_sub_u32 v218, v126, v210
  v_ashrrev_i32 v218, 31, v218
  v_bfi_b32 v218, v218, 0, s33
  v_add_u32 v133, v133, v218
  s_waitcnt lgkmcnt(3)
  v_sub_u32 v219, v127, v211
  v_ashrrev_i32 v219, 31, v219
  v_bfi_b32 v219, v219, 0, s33
  v_add_u32 v134, v134, v219
  s_waitcnt lgkmcnt(2)
  v_sub_u32 v220, v128, v212
  v_ashrrev_i32 v220, 31, v220
  v_bfi_b32 v220, v220, 0, s33
  v_add_u32 v135, v135, v220
  s_waitcnt lgkmcnt(1)
  v_sub_u32 v221, v129, v213
  v_ashrrev_i32 v221, 31, v221
  v_bfi_b32 v221, v221, 0, s33
  v_add_u32 v136, v136, v221
  s_waitcnt lgkmcnt(0)
  v_sub_u32 v222, v130, v214
  v_ashrrev_i32 v222, 31, v222
  v_bfi_b32 v222, v222, 0, s33
  v_add_u32 v137, v137, v222
  ds_read_b32 v208, v131 offset:4448
  ds_read_b32 v209, v132 offset:4448
  ds_read_b32 v210, v133 offset:4448
  ds_read_b32 v211, v134 offset:4448
  ds_read_b32 v212, v135 offset:4448
  ds_read_b32 v213, v136 offset:4448
  ds_read_b32 v214, v137 offset:4448
  s_waitcnt lgkmcnt(6)
  v_sub_u32 v216, v124, v208
  v_ashrrev_i32 v216, 31, v216
  v_bfi_b32 v216, v216, 0, 64
  v_add_u32 v131, v131, v216
  s_waitcnt lgkmcnt(5)
  v_sub_u32 v217, v125, v209
  v_ashrrev_i32 v217, 31, v217
  v_bfi_b32 v217, v217, 0, 64
  v_add_u32 v132, v132, v217
  s_waitcnt lgkmcnt(4)
  v_sub_u32 v218, v126, v210
  v_ashrrev_i32 v218, 31, v218
  v_bfi_b32 v218, v218, 0, 64
  v_add_u32 v133, v133, v218
  s_waitcnt lgkmcnt(3)
  v_sub_u32 v219, v127, v211
  v_ashrrev_i32 v219, 31, v219
  v_bfi_b32 v219, v219, 0, 64
  v_add_u32 v134, v134, v219
  s_waitcnt lgkmcnt(2)
  v_sub_u32 v220, v128, v212
  v_ashrrev_i32 v220, 31, v220
  v_bfi_b32 v220, v220, 0, 64
  v_add_u32 v135, v135, v220
  s_waitcnt lgkmcnt(1)
  v_sub_u32 v221, v129, v213
  v_ashrrev_i32 v221, 31, v221
  v_bfi_b32 v221, v221, 0, 64
  v_add_u32 v136, v136, v221
  s_waitcnt lgkmcnt(0)
  v_sub_u32 v222, v130, v214
  v_ashrrev_i32 v222, 31, v222
  v_bfi_b32 v222, v222, 0, 64
  v_add_u32 v137, v137, v222
  ds_read_b32 v208, v131 offset:4416
  ds_read_b32 v209, v132 offset:4416
  ds_read_b32 v210, v133 offset:4416
  ds_read_b32 v211, v134 offset:4416
  ds_read_b32 v212, v135 offset:4416
  ds_read_b32 v213, v136 offset:4416
  ds_read_b32 v214, v137 offset:4416
  s_waitcnt lgkmcnt(6)
  v_sub_u32 v216, v124, v208
  v_ashrrev_i32 v216, 31, v216
  v_bfi_b32 v216, v216, 0, 32
  v_add_u32 v131, v131, v216
  s_waitcnt lgkmcnt(5)
  v_sub_u32 v217, v125, v209
  v_ashrrev_i32 v217, 31, v217
  v_bfi_b32 v217, v217, 0, 32
  v_add_u32 v132, v132, v217
  s_waitcnt lgkmcnt(4)
  v_sub_u32 v218, v126, v210
  v_ashrrev_i32 v218, 31, v218
  v_bfi_b32 v218, v218, 0, 32
  v_add_u32 v133, v133, v218
  s_waitcnt lgkmcnt(3)
  v_sub_u32 v219, v127, v211
  v_ashrrev_i32 v219, 31, v219
  v_bfi_b32 v219, v219, 0, 32
  v_add_u32 v134, v134, v219
  s_waitcnt lgkmcnt(2)
  v_sub_u32 v220, v128, v212
  v_ashrrev_i32 v220, 31, v220
  v_bfi_b32 v220, v220, 0, 32
  v_add_u32 v135, v135, v220
  s_waitcnt lgkmcnt(1)
  v_sub_u32 v221, v129, v213
  v_ashrrev_i32 v221, 31, v221
  v_bfi_b32 v221, v221, 0, 32
  v_add_u32 v136, v136, v221
  s_waitcnt lgkmcnt(0)
  v_sub_u32 v222, v130, v214
  v_ashrrev_i32 v222, 31, v222
  v_bfi_b32 v222, v222, 0, 32
  v_add_u32 v137, v137, v222
  ds_read_b32 v208, v131 offset:4400
  ds_read_b32 v209, v132 offset:4400
  ds_read_b32 v210, v133 offset:4400
  ds_read_b32 v211, v134 offset:4400
  ds_read_b32 v212, v135 offset:4400
  ds_read_b32 v213, v136 offset:4400
  ds_read_b32 v214, v137 offset:4400
  s_waitcnt lgkmcnt(6)
  v_sub_u32 v216, v124, v208
  v_ashrrev_i32 v216, 31, v216
  v_bfi_b32 v216, v216, 0, 16
  v_add_u32 v131, v131, v216
  s_waitcnt lgkmcnt(5)
  v_sub_u32 v217, v125, v209
  v_ashrrev_i32 v217, 31, v217
  v_bfi_b32 v217, v217, 0, 16
  v_add_u32 v132, v132, v217
  s_waitcnt lgkmcnt(4)
  v_sub_u32 v218, v126, v210
  v_ashrrev_i32 v218, 31, v218
  v_bfi_b32 v218, v218, 0, 16
  v_add_u32 v133, v133, v218
  s_waitcnt lgkmcnt(3)
  v_sub_u32 v219, v127, v211
  v_ashrrev_i32 v219, 31, v219
  v_bfi_b32 v219, v219, 0, 16
  v_add_u32 v134, v134, v219
  s_waitcnt lgkmcnt(2)
  v_sub_u32 v220, v128, v212
  v_ashrrev_i32 v220, 31, v220
  v_bfi_b32 v220, v220, 0, 16
  v_add_u32 v135, v135, v220
  s_waitcnt lgkmcnt(1)
  v_sub_u32 v221, v129, v213
  v_ashrrev_i32 v221, 31, v221
  v_bfi_b32 v221, v221, 0, 16
  v_add_u32 v136, v136, v221
  s_waitcnt lgkmcnt(0)
  v_sub_u32 v222, v130, v214
  v_ashrrev_i32 v222, 31, v222
  v_bfi_b32 v222, v222, 0, 16
  v_add_u32 v137, v137, v222
  ds_read_b32 v208, v131 offset:4392
  ds_read_b32 v209, v132 offset:4392
  ds_read_b32 v210, v133 offset:4392
  ds_read_b32 v211, v134 offset:4392
  ds_read_b32 v212, v135 offset:4392
  ds_read_b32 v213, v136 offset:4392
  ds_read_b32 v214, v137 offset:4392
  s_waitcnt lgkmcnt(6)
  v_sub_u32 v216, v124, v208
  v_ashrrev_i32 v216, 31, v216
  v_bfi_b32 v216, v216, 0, 8
  v_add_u32 v131, v131, v216
  s_waitcnt lgkmcnt(5)
  v_sub_u32 v217, v125, v209
  v_ashrrev_i32 v217, 31, v217
  v_bfi_b32 v217, v217, 0, 8
  v_add_u32 v132, v132, v217
  s_waitcnt lgkmcnt(4)
  v_sub_u32 v218, v126, v210
  v_ashrrev_i32 v218, 31, v218
  v_bfi_b32 v218, v218, 0, 8
  v_add_u32 v133, v133, v218
  s_waitcnt lgkmcnt(3)
  v_sub_u32 v219, v127, v211
  v_ashrrev_i32 v219, 31, v219
  v_bfi_b32 v219, v219, 0, 8
  v_add_u32 v134, v134, v219
  s_waitcnt lgkmcnt(2)
  v_sub_u32 v220, v128, v212
  v_ashrrev_i32 v220, 31, v220
  v_bfi_b32 v220, v220, 0, 8
  v_add_u32 v135, v135, v220
  s_waitcnt lgkmcnt(1)
  v_sub_u32 v221, v129, v213
  v_ashrrev_i32 v221, 31, v221
  v_bfi_b32 v221, v221, 0, 8
  v_add_u32 v136, v136, v221
  s_waitcnt lgkmcnt(0)
  v_sub_u32 v222, v130, v214
  v_ashrrev_i32 v222, 31, v222
  v_bfi_b32 v222, v222, 0, 8
  v_add_u32 v137, v137, v222
  ds_read_b32 v208, v131 offset:4388
  ds_read_b32 v209, v132 offset:4388
  ds_read_b32 v210, v133 offset:4388
  ds_read_b32 v211, v134 offset:4388
  ds_read_b32 v212, v135 offset:4388
  ds_read_b32 v213, v136 offset:4388
  ds_read_b32 v214, v137 offset:4388
  s_waitcnt lgkmcnt(6)
  v_sub_u32 v216, v124, v208
  v_ashrrev_i32 v216, 31, v216
  v_bfi_b32 v216, v216, 0, 4
  v_add_u32 v131, v131, v216
  s_waitcnt lgkmcnt(5)
  v_sub_u32 v217, v125, v209
  v_ashrrev_i32 v217, 31, v217
  v_bfi_b32 v217, v217, 0, 4
  v_add_u32 v132, v132, v217
  s_waitcnt lgkmcnt(4)
  v_sub_u32 v218, v126, v210
  v_ashrrev_i32 v218, 31, v218
  v_bfi_b32 v218, v218, 0, 4
  v_add_u32 v133, v133, v218
  s_waitcnt lgkmcnt(3)
  v_sub_u32 v219, v127, v211
  v_ashrrev_i32 v219, 31, v219
  v_bfi_b32 v219, v219, 0, 4
  v_add_u32 v134, v134, v219
  s_waitcnt lgkmcnt(2)
  v_sub_u32 v220, v128, v212
  v_ashrrev_i32 v220, 31, v220
  v_bfi_b32 v220, v220, 0, 4
  v_add_u32 v135, v135, v220
  s_waitcnt lgkmcnt(1)
  v_sub_u32 v221, v129, v213
  v_ashrrev_i32 v221, 31, v221
  v_bfi_b32 v221, v221, 0, 4
  v_add_u32 v136, v136, v221
  s_waitcnt lgkmcnt(0)
  v_sub_u32 v222, v130, v214
  v_ashrrev_i32 v222, 31, v222
  v_bfi_b32 v222, v222, 0, 4
  v_add_u32 v137, v137, v222
  ds_read_b32 v208, v131 offset:5424
  ds_read_b32 v209, v132 offset:5424
  ds_read_b32 v210, v133 offset:5424
  ds_read_b32 v211, v134 offset:5424
  ds_read_b32 v212, v135 offset:5424
  ds_read_b32 v213, v136 offset:5424
  ds_read_b32 v214, v137 offset:5424
  v_mov_b32 v87, 0x80000000
  s_waitcnt lgkmcnt(6)
  v_add_u32 v208, v208, v124
  v_mul_u32_u24 v208, 12, v208
  v_cmp_gt_u32 s[46:47], s39, v124
s_nop 1
  v_cndmask_b32_e64 v208, v87, v208, s[46:47]
  buffer_load_dwordx3 v[96:98], v208, s[12:15], 0 offen
  s_waitcnt lgkmcnt(5)
  v_add_u32 v209, v209, v125
  v_mul_u32_u24 v209, 12, v209
  v_cmp_gt_u32 s[46:47], s39, v125
s_nop 1
  v_cndmask_b32_e64 v209, v87, v209, s[46:47]
  buffer_load_dwordx3 v[100:102], v209, s[12:15], 0 offen
  s_waitcnt lgkmcnt(4)
  v_add_u32 v210, v210, v126
  v_mul_u32_u24 v210, 12, v210
  v_cmp_gt_u32 s[46:47], s39, v126
s_nop 1
  v_cndmask_b32_e64 v210, v87, v210, s[46:47]
  buffer_load_dwordx3 v[104:106], v210, s[12:15], 0 offen
  s_waitcnt lgkmcnt(3)
  v_add_u32 v211, v211, v127
  v_mul_u32_u24 v211, 12, v211
  v_cmp_gt_u32 s[46:47], s39, v127
s_nop 1
  v_cndmask_b32_e64 v211, v87, v211, s[46:47]
  buffer_load_dwordx3 v[108:110], v211, s[12:15], 0 offen
  s_waitcnt lgkmcnt(2)
  v_add_u32 v212, v212, v128
  v_mul_u32_u24 v212, 12, v212
  v_cmp_gt_u32 s[46:47], s39, v128
s_nop 1
  v_cndmask_b32_e64 v212, v87, v212, s[46:47]
  buffer_load_dwordx3 v[112:114], v212, s[12:15], 0 offen
  s_waitcnt lgkmcnt(1)
  v_add_u32 v213, v213, v129
  v_mul_u32_u24 v213, 12, v213
  v_cmp_gt_u32 s[46:47], s39, v129
s_nop 1
  v_cndmask_b32_e64 v213, v87, v213, s[46:47]
  buffer_load_dwordx3 v[116:118], v213, s[12:15], 0 offen
  s_waitcnt lgkmcnt(0)
  v_add_u32 v214, v214, v130
  v_mul_u32_u24 v214, 12, v214
  v_cmp_gt_u32 s[46:47], s39, v130
s_nop 1
  v_cndmask_b32_e64 v214, v87, v214, s[46:47]
  buffer_load_dwordx3 v[120:122], v214, s[12:15], 0 offen
  v_mov_b32 v86, 1
  v_cmp_gt_u32 vcc, s39, v124
s_nop 0
  s_and_saveexec_b64 s[44:45], vcc
  s_waitcnt vmcnt(6)
  v_and_b32 v131, 0x3fc, v97
  ds_add_rtn_u32 v208, v131, v86 offset:2304
  v_bfe_u32 v99, v97, 10, 5
  v_lshlrev_b32 v99, 5, v99
  v_and_or_b32 v97, v97, s23, v99
  s_mov_b64 exec, s[44:45]
  v_cmp_gt_u32 vcc, s39, v125
s_nop 0
  s_and_saveexec_b64 s[44:45], vcc
  s_waitcnt vmcnt(5)
  v_and_b32 v132, 0x3fc, v101
  ds_add_rtn_u32 v209, v132, v86 offset:2304
  v_bfe_u32 v103, v101, 10, 5
  v_lshlrev_b32 v103, 5, v103
  v_and_or_b32 v101, v101, s23, v103
  s_mov_b64 exec, s[44:45]
  v_cmp_gt_u32 vcc, s39, v126
s_nop 0
  s_and_saveexec_b64 s[44:45], vcc
  s_waitcnt vmcnt(4)
  v_and_b32 v133, 0x3fc, v105
  ds_add_rtn_u32 v210, v133, v86 offset:2304
  v_bfe_u32 v107, v105, 10, 5
  v_lshlrev_b32 v107, 5, v107
  v_and_or_b32 v105, v105, s23, v107
  s_mov_b64 exec, s[44:45]
  v_cmp_gt_u32 vcc, s39, v127
s_nop 0
  s_and_saveexec_b64 s[44:45], vcc
  s_waitcnt vmcnt(3)
  v_and_b32 v134, 0x3fc, v109
  ds_add_rtn_u32 v211, v134, v86 offset:2304
  v_bfe_u32 v111, v109, 10, 5
  v_lshlrev_b32 v111, 5, v111
  v_and_or_b32 v109, v109, s23, v111
  s_mov_b64 exec, s[44:45]
  v_cmp_gt_u32 vcc, s39, v128
s_nop 0
  s_and_saveexec_b64 s[44:45], vcc
  s_waitcnt vmcnt(2)
  v_and_b32 v135, 0x3fc, v113
  ds_add_rtn_u32 v212, v135, v86 offset:2304
  v_bfe_u32 v115, v113, 10, 5
  v_lshlrev_b32 v115, 5, v115
  v_and_or_b32 v113, v113, s23, v115
  s_mov_b64 exec, s[44:45]
  v_cmp_gt_u32 vcc, s39, v129
s_nop 0
  s_and_saveexec_b64 s[44:45], vcc
  s_waitcnt vmcnt(1)
  v_and_b32 v136, 0x3fc, v117
  ds_add_rtn_u32 v213, v136, v86 offset:2304
  v_bfe_u32 v119, v117, 10, 5
  v_lshlrev_b32 v119, 5, v119
  v_and_or_b32 v117, v117, s23, v119
  s_mov_b64 exec, s[44:45]
  v_cmp_gt_u32 vcc, s39, v130
s_nop 0
  s_and_saveexec_b64 s[44:45], vcc
  s_waitcnt vmcnt(0)
  v_and_b32 v137, 0x3fc, v121
  ds_add_rtn_u32 v214, v137, v86 offset:2304
  v_bfe_u32 v123, v121, 10, 5
  v_lshlrev_b32 v123, 5, v123
  v_and_or_b32 v121, v121, s23, v123
  s_mov_b64 exec, s[44:45]
  s_waitcnt lgkmcnt(0)
  s_barrier
  v_lshlrev_b32 v86, 4, v80
  ds_read_b128 v[216:219], v86 offset:2304
  s_waitcnt lgkmcnt(0)
  v_add_u32 v225, v216, v217
  v_add_u32 v226, v225, v218
  v_add_u32 v227, v226, v219
  v_mov_b32 v224, v227
s_nop 1
  v_add_u32_dpp v224, v224, v224 row_shr:1 row_mask:0xf bank_mask:0xf
s_nop 1
  v_add_u32_dpp v224, v224, v224 row_shr:2 row_mask:0xf bank_mask:0xf
s_nop 1
  v_add_u32_dpp v224, v224, v224 row_shr:4 row_mask:0xf bank_mask:0xf
s_nop 1
  v_add_u32_dpp v224, v224, v224 row_shr:8 row_mask:0xf bank_mask:0xf
s_nop 1
  v_add_u32_dpp v224, v224, v224 row_bcast:15 row_mask:0xa bank_mask:0xf
s_nop 1
  v_add_u32_dpp v224, v224, v224 row_bcast:31 row_mask:0xc bank_mask:0xf
  v_sub_u32 v220, v224, v227
  v_add_u32 v221, v220, v216
  v_add_u32 v222, v220, v225
  v_add_u32 v223, v220, v226
  ds_write_b128 v86, v[220:223] offset:3328
  ds_read_b32 v216, v131 offset:3328
  ds_read_b32 v217, v132 offset:3328
  ds_read_b32 v218, v133 offset:3328
  ds_read_b32 v219, v134 offset:3328
  ds_read_b32 v220, v135 offset:3328
  ds_read_b32 v221, v136 offset:3328
  ds_read_b32 v222, v137 offset:3328
  v_cmp_gt_u32 vcc, s39, v124
s_nop 0
  s_and_saveexec_b64 s[44:45], vcc
  s_waitcnt lgkmcnt(6)
  v_add_u32 v216, v216, v208
  v_lshlrev_b32 v216, 4, v216
  ds_write_b128 v216, v[96:99] offset:8192
  s_mov_b64 exec, s[44:45]
  v_cmp_gt_u32 vcc, s39, v125
s_nop 0
  s_and_saveexec_b64 s[44:45], vcc
  s_waitcnt lgkmcnt(6)
  v_add_u32 v217, v217, v209
  v_lshlrev_b32 v217, 4, v217
  ds_write_b128 v217, v[100:103] offset:8192
  s_mov_b64 exec, s[44:45]
  v_cmp_gt_u32 vcc, s39, v126
s_nop 0
  s_and_saveexec_b64 s[44:45], vcc
  s_waitcnt lgkmcnt(6)
  v_add_u32 v218, v218, v210
  v_lshlrev_b32 v218, 4, v218
  ds_write_b128 v218, v[104:107] offset:8192
  s_mov_b64 exec, s[44:45]
  v_cmp_gt_u32 vcc, s39, v127
s_nop 0
  s_and_saveexec_b64 s[44:45], vcc
  s_waitcnt lgkmcnt(6)
  v_add_u32 v219, v219, v211
  v_lshlrev_b32 v219, 4, v219
  ds_write_b128 v219, v[108:111] offset:8192
  s_mov_b64 exec, s[44:45]
  v_cmp_gt_u32 vcc, s39, v128
s_nop 0
  s_and_saveexec_b64 s[44:45], vcc
  s_waitcnt lgkmcnt(6)
  v_add_u32 v220, v220, v212
  v_lshlrev_b32 v220, 4, v220
  ds_write_b128 v220, v[112:115] offset:8192
  s_mov_b64 exec, s[44:45]
  v_cmp_gt_u32 vcc, s39, v129
s_nop 0
  s_and_saveexec_b64 s[44:45], vcc
  s_waitcnt lgkmcnt(6)
  v_add_u32 v221, v221, v213
  v_lshlrev_b32 v221, 4, v221
  ds_write_b128 v221, v[116:119] offset:8192
  s_mov_b64 exec, s[44:45]
  v_cmp_gt_u32 vcc, s39, v130
s_nop 0
  s_and_saveexec_b64 s[44:45], vcc
  s_waitcnt lgkmcnt(6)
  v_add_u32 v222, v222, v214
  v_lshlrev_b32 v222, 4, v222
  ds_write_b128 v222, v[120:123] offset:8192
  s_mov_b64 exec, s[44:45]
  s_sub_u32 s32, s39, s38
  v_add_u32 v86, s32, v95
  v_lshlrev_b32 v86, 4, v86
  v_mov_b32 v216, 0
  v_mov_b32 v217, 0
  v_mov_b32 v218, 0
  v_mov_b32 v219, 0
  v_cmp_gt_u32 vcc, 64, v95
s_nop 0
  s_and_saveexec_b64 s[44:45], vcc
  ds_write_b128 v86, v[216:219] offset:8192
  s_mov_b64 exec, s[44:45]
  s_waitcnt lgkmcnt(0)
  s_barrier
  v_lshlrev_b32 v86, 2, v95
  v_mov_b32 v87, 0
  v_cmp_gt_u32 vcc, 256, v95
s_nop 0
  s_and_saveexec_b64 s[44:45], vcc
  ds_write_b32 v86, v87 offset:2304
  s_mov_b64 exec, s[44:45]
  s_lshl_b32 s32, s34, 2
  s_add_u32 s33, s34, s35
  s_lshl_b32 s33, s33, 2
  v_mov_b32 v86, s32
  v_mov_b32 v89, s33
  ds_read_b32 v87, v86 offset:3328
  ds_read_b32 v88, v89 offset:3328
  v_lshl_add_u32 v89, v85, 2, s32
  v_max_i32 v89, v89, v86
  v_add_u32 v89, 3328, v89
  ds_read2_b32 v[90:91], v89 offset0:0 offset1:1
  s_waitcnt lgkmcnt(2)
  v_readfirstlane_b32 s32, v87
  s_waitcnt lgkmcnt(1)
  v_readfirstlane_b32 s33, v88
s_nop 0
  s_sub_u32 s25, s33, s32
  s_add_u32 s25, s25, 31
  s_lshr_b32 s25, s25, 5
  s_min_u32 s25, s25, 128
  v_lshrrev_b32 v86, v81, s36
  v_and_b32 v86, 1, v86
  v_cmp_eq_u32 vcc, 1, v86
  v_mov_b32 v87, s32
  s_waitcnt lgkmcnt(0)
s_nop 0
  v_cndmask_b32 v90, v87, v90, vcc
  v_cndmask_b32 v91, v87, v91, vcc
  v_lshl_add_u32 v87, v82, 2, s32
  v_sub_u32 v236, v90, v87
  v_sub_u32 v237, v91, v87
  v_lshrrev_b32 v86, 3, v80
  v_add_u32 v86, s32, v86
  v_lshlrev_b32 v86, 4, v86
  v_add_u32 v234, 8198, v86
  v_add_u32 v86, s32, v81
  v_lshlrev_b32 v86, 4, v86
  v_lshl_add_u32 v86, v82, 3, v86
  v_add_u32 v235, 8192, v86
  s_mov_b32 s26, 0
  ds_read_u16 v240, v234 offset:0
  ds_read_u16 v241, v234 offset:128
  ds_read_u16 v242, v234 offset:256
  ds_read_u16 v243, v234 offset:384
  s_add_u32 s29, s26, 0
  s_cmp_lt_u32 s29, s25
  s_cselect_b32 s28, 0, 0x80000000
  s_waitcnt lgkmcnt(3)
  v_lshl_add_u32 v240, v240, 7, v232
  s_waitcnt lgkmcnt(2)
  v_lshl_add_u32 v241, v241, 7, v232
  s_waitcnt lgkmcnt(1)
  v_lshl_add_u32 v242, v242, 7, v232
  s_waitcnt lgkmcnt(0)
  v_lshl_add_u32 v243, v243, 7, v232
  s_add_u32 m0, s27, 0
s_nop 0
  buffer_load_dwordx4 v240, s[8:11], s28 offen lds
  s_add_u32 m0, s27, 1056
s_nop 0
  buffer_load_dwordx4 v241, s[8:11], s28 offen lds
  s_add_u32 m0, s27, 2112
s_nop 0
  buffer_load_dwordx4 v242, s[8:11], s28 offen lds
  s_add_u32 m0, s27, 3168
s_nop 0
  buffer_load_dwordx4 v243, s[8:11], s28 offen lds
  ds_read_u16 v240, v234 offset:512
  ds_read_u16 v241, v234 offset:640
  ds_read_u16 v242, v234 offset:768
  ds_read_u16 v243, v234 offset:896
  s_add_u32 s29, s26, 1
  s_cmp_lt_u32 s29, s25
  s_cselect_b32 s28, 0, 0x80000000
  s_waitcnt lgkmcnt(3)
  v_lshl_add_u32 v240, v240, 7, v232
  s_waitcnt lgkmcnt(2)
  v_lshl_add_u32 v241, v241, 7, v232
  s_waitcnt lgkmcnt(1)
  v_lshl_add_u32 v242, v242, 7, v232
  s_waitcnt lgkmcnt(0)
  v_lshl_add_u32 v243, v243, 7, v232
  s_add_u32 m0, s27, 4224
s_nop 0
  buffer_load_dwordx4 v240, s[8:11], s28 offen lds
  s_add_u32 m0, s27, 5280
s_nop 0
  buffer_load_dwordx4 v241, s[8:11], s28 offen lds
  s_add_u32 m0, s27, 6336
s_nop 0
  buffer_load_dwordx4 v242, s[8:11], s28 offen lds
  s_add_u32 m0, s27, 7392
s_nop 0
  buffer_load_dwordx4 v243, s[8:11], s28 offen lds
  ds_read_b64 v[224:225], v235 offset:0
  s_waitcnt vmcnt(4)
  ds_read_b128 v[208:211], v233 offset:0
  ds_read_b128 v[212:215], v233 offset:32
  ds_read_b128 v[216:219], v233 offset:64
  ds_read_b128 v[220:223], v233 offset:96
  ds_read_u16 v240, v234 offset:1024
  ds_read_u16 v241, v234 offset:1152
  ds_read_u16 v242, v234 offset:1280
  ds_read_u16 v243, v234 offset:1408
  s_waitcnt lgkmcnt(8)
  v_and_or_b32 v239, v225, s21, v238
  ds_read_b32 v225, v239 offset:4
  ds_read_b64 v[226:227], v239 offset:8
  ds_read_b128 v[228:231], v239 offset:16
  s_add_u32 s29, s26, 2
  s_cmp_lt_u32 s29, s25
  s_cselect_b32 s28, 0, 0x80000000
  s_waitcnt lgkmcnt(6)
  v_lshl_add_u32 v240, v240, 7, v232
  s_waitcnt lgkmcnt(5)
  v_lshl_add_u32 v241, v241, 7, v232
  s_waitcnt lgkmcnt(4)
  v_lshl_add_u32 v242, v242, 7, v232
  s_waitcnt lgkmcnt(3)
  v_lshl_add_u32 v243, v243, 7, v232
  s_add_u32 m0, s27, 0
s_nop 0
  buffer_load_dwordx4 v240, s[8:11], s28 offen lds
  s_add_u32 m0, s27, 1056
s_nop 0
  buffer_load_dwordx4 v241, s[8:11], s28 offen lds
  s_add_u32 m0, s27, 2112
s_nop 0
  buffer_load_dwordx4 v242, s[8:11], s28 offen lds
  s_add_u32 m0, s27, 3168
s_nop 0
  buffer_load_dwordx4 v243, s[8:11], s28 offen lds
  v_mfma_f32_32x32x16_bf16 v[80:95], v[208:211], v[0:3], 0
  v_mfma_f32_32x32x16_bf16 v[80:95], v[212:215], v[8:11], v[80:95]
  v_mfma_f32_32x32x16_bf16 v[80:95], v[216:219], v[16:19], v[80:95]
  v_mfma_f32_32x32x16_bf16 v[80:95], v[220:223], v[24:27], v[80:95]
  s_waitcnt lgkmcnt(1)
  v_mfma_f32_32x32x16_bf16 v[80:95], v[224:227], v[64:67], v[80:95]
  s_waitcnt lgkmcnt(0)
  v_mfma_f32_32x32x16_bf16 v[80:95], v[228:231], v[72:75], v[80:95]
  v_mfma_f32_32x32x16_bf16 v[112:127], v[208:211], v[32:35], 0
  v_mfma_f32_32x32x16_bf16 v[112:127], v[212:215], v[40:43], v[112:127]
  v_mfma_f32_32x32x16_bf16 v[112:127], v[216:219], v[48:51], v[112:127]
  v_mfma_f32_32x32x16_bf16 v[112:127], v[220:223], v[56:59], v[112:127]
K3_SORTED:
  s_lshl_b32 s94, s3, 2
  s_add_u32 s94, s94, 8000
  s_xor_b32 s95, s94, 16
  s_cmp_eq_u32 s25, 0
  s_cbranch_scc1 K3_NEXT
K3_LOOP:
  v_mfma_f32_32x32x16_bf16 v[96:111], v[208:211], v[4:7], 0
  v_mov_b32 v246, s95
  ds_read_b32 v246, v246
  v_mov_b32 v244, s94
  v_mov_b32 v245, s26
  ds_write_b32 v244, v245
  v_med3_i32 v244, v236, 0, 28
  v_mfma_f32_32x32x16_bf16 v[128:143], v[208:211], v[36:39], 0
  v_med3_i32 v245, v237, 0, 28
  v_lshlrev_b32_e64 v245, v245, 8
  v_lshlrev_b32_e64 v244, v244, 8
  v_mul_f32 v80, s20, v80
  v_exp_f32 v80, v80
  v_mfma_f32_32x32x16_bf16 v[96:111], v[212:215], v[12:15], v[96:111]
  v_mul_f32 v81, s20, v81
  v_exp_f32 v81, v81
  v_mul_f32 v82, s20, v82
  v_mul_f32 v83, s20, v83
  v_exp_f32 v82, v82
  v_mfma_f32_32x32x16_bf16 v[128:143], v[212:215], v[44:47], v[128:143]
  v_exp_f32 v83, v83
  v_mul_f32 v84, s20, v84
  v_mul_f32 v85, s20, v85
  s_waitcnt lgkmcnt(1)
  v_readfirstlane_b32 s93, v246
  v_sub_u32 v246, v245, v244
  v_mfma_f32_32x32x16_bf16 v[96:111], v[216:219], v[20:23], v[96:111]
  v_and_b32 v244, 0x78, v246
  v_and_b32_sdwa v245, s24, v246 dst_sel:DWORD dst_unused:UNUSED_PAD src0_sel:DWORD src1_sel:BYTE_1
  ds_read_b64 v[248:249], v244 offset:2048
  ds_read_b64 v[250:251], v245 offset:2048
  v_and_b32_sdwa v247, s24, v246 dst_sel:DWORD dst_unused:UNUSED_PAD src0_sel:DWORD src1_sel:BYTE_2
  v_and_b32_sdwa v246, s24, v246 dst_sel:DWORD dst_unused:UNUSED_PAD src0_sel:DWORD src1_sel:BYTE_3
  v_mfma_f32_32x32x16_bf16 v[128:143], v[216:219], v[52:55], v[128:143]
  ds_read_b64 v[252:253], v247 offset:2048
  ds_read_b64 v[254:255], v246 offset:2048
  v_mul_f32 v86, s20, v86
  v_mul_f32 v87, s20, v87
  v_add_f32 v80, 1.0, v80
  v_exp_f32 v84, v84
  v_mfma_f32_32x32x16_bf16 v[96:111], v[220:223], v[28:31], v[96:111]
  v_exp_f32 v85, v85
  v_exp_f32 v86, v86
  v_exp_f32 v87, v87
  v_mfma_f32_32x32x16_bf16 v[128:143], v[220:223], v[60:63], v[128:143]
  v_rcp_f32 v80, v80
  v_add_f32 v81, 1.0, v81
  s_waitcnt vmcnt(4)
  ds_read_b128 v[208:211], v233 offset:4224
  v_mul_f32 v88, s20, v88
  v_rcp_f32 v81, v81
  v_mfma_f32_32x32x16_bf16 v[96:111], v[224:227], v[68:71], v[96:111]
  v_add_f32 v82, 1.0, v82
  v_add_f32 v83, 1.0, v83
  ds_read_u16 v240, v234 offset:1536
  v_exp_f32 v88, v88
  v_mul_f32 v89, s20, v89
  v_mfma_f32_32x32x16_bf16 v[96:111], v[228:231], v[76:79], v[96:111]
  v_rcp_f32 v82, v82
  v_rcp_f32 v83, v83
  v_add_f32 v84, 1.0, v84
  v_add_f32 v85, 1.0, v85
  v_add_f32 v86, 1.0, v86
  v_add_f32 v87, 1.0, v87
  ds_read_b128 v[212:215], v233 offset:4256
  ds_read_b128 v[216:219], v233 offset:4288
  ds_read_b128 v[220:223], v233 offset:4320
  v_mul_f32 v112, v80, v112
  v_exp_f32 v89, v89
  v_mul_f32 v90, s20, v90
  v_mul_f32 v91, s20, v91
  v_rcp_f32 v84, v84
  v_rcp_f32 v85, v85
  v_rcp_f32 v86, v86
  v_rcp_f32 v87, v87
  v_mul_f32 v113, v81, v113
  v_exp_f32 v90, v90
  v_exp_f32 v91, v91
  v_mul_f32 v92, s20, v92
  v_mul_f32 v93, s20, v93
  v_mul_f32 v94, s20, v94
  v_mul_f32 v95, s20, v95
  v_cvt_pk_bf16_f32 v80, v80, v81
  v_add_f32 v88, 1.0, v88
  v_mul_f32 v114, v82, v114
  v_mul_f32 v115, v83, v115
  v_exp_f32 v92, v92
  v_exp_f32 v93, v93
  v_exp_f32 v94, v94
  v_exp_f32 v95, v95
  v_cvt_pk_bf16_f32 v81, v82, v83
  v_rcp_f32 v88, v88
  v_add_f32 v89, 1.0, v89
  ds_read_b64 v[224:225], v235 offset:512
  v_cvt_pk_bf16_f32 v82, v84, v85
  v_cvt_pk_bf16_f32 v83, v86, v87
  v_rcp_f32 v89, v89
  s_waitcnt lgkmcnt(8)
s_nop 0
  v_mfma_f32_32x32x16_bf16 v[144:159], v[248:251], v[80:83], v[144:159]
  v_add_f32 v90, 1.0, v90
  v_add_f32 v91, 1.0, v91
  v_rcp_f32 v90, v90
  v_rcp_f32 v91, v91
  v_add_f32 v92, 1.0, v92
  v_add_f32 v93, 1.0, v93
  v_add_f32 v94, 1.0, v94
  v_add_f32 v95, 1.0, v95
  v_mul_f32 v120, v88, v120
  v_rcp_f32 v92, v92
  v_rcp_f32 v93, v93
  v_rcp_f32 v94, v94
  v_rcp_f32 v95, v95
  ds_read_u16 v241, v234 offset:1664
  v_mul_f32 v121, v89, v121
  v_cvt_pk_bf16_f32 v88, v88, v89
  v_mul_f32 v122, v90, v122
  v_mul_f32 v123, v91, v123
  v_cvt_pk_bf16_f32 v89, v90, v91
  v_cvt_pk_bf16_f32 v90, v92, v93
  v_cvt_pk_bf16_f32 v91, v94, v95
  s_add_u32 s29, s26, 3
  v_mul_f32 v116, v84, v116
  s_waitcnt lgkmcnt(7)
  v_mfma_f32_32x32x16_bf16 v[144:159], v[252:255], v[88:91], v[144:159]
  v_mul_f32 v117, v85, v117
  v_mul_f32 v118, v86, v118
  v_mul_f32 v119, v87, v119
  v_mul_f32 v124, v92, v124
  v_mul_f32 v125, v93, v125
  v_mul_f32 v126, v94, v126
  v_mul_f32 v127, v95, v127
  s_waitcnt lgkmcnt(6)
  v_mfma_f32_32x32x16_bf16 v[80:95], v[208:211], v[0:3], 0
  v_cvt_pk_bf16_f32 v112, v112, v113
  s_cmp_lt_u32 s29, s25
  v_cvt_pk_bf16_f32 v113, v114, v115
  s_cselect_b32 s28, 0, 0x80000000
  ds_read_u16 v242, v234 offset:1792
  v_cvt_pk_bf16_f32 v114, v116, v117
  s_waitcnt lgkmcnt(5)
  v_mfma_f32_32x32x16_bf16 v[80:95], v[212:215], v[8:11], v[80:95]
  v_cvt_pk_bf16_f32 v115, v118, v119
  v_lshl_add_u32 v240, v240, 7, v232
  s_add_u32 m0, s27, 4224
  s_waitcnt lgkmcnt(3)
s_nop 0
  buffer_load_dwordx4 v240, s[8:11], s28 offen lds
  v_mfma_f32_32x32x16_bf16 v[176:191], v[248:251], v[112:115], v[176:191]
  v_cvt_pk_bf16_f32 v120, v120, v121
  s_waitcnt lgkmcnt(2)
  v_and_or_b32 v239, v225, s21, v238
  v_cvt_pk_bf16_f32 v121, v122, v123
  ds_read_b32 v225, v239 offset:4
  ds_read_b64 v[226:227], v239 offset:8
  v_cvt_pk_bf16_f32 v122, v124, v125
  v_mfma_f32_32x32x16_bf16 v[80:95], v[216:219], v[16:19], v[80:95]
  v_cvt_pk_bf16_f32 v123, v126, v127
  ds_read_u16 v243, v234 offset:1920
  v_mul_f32 v96, s20, v96
  v_mul_f32 v97, s20, v97
  s_waitcnt lgkmcnt(4)
  v_lshl_add_u32 v241, v241, 7, v232
  s_add_u32 m0, s27, 5280
  v_mfma_f32_32x32x16_bf16 v[176:191], v[252:255], v[120:123], v[176:191]
  v_exp_f32 v96, v96
  v_exp_f32 v97, v97
  v_mul_f32 v98, s20, v98
  v_mul_f32 v99, s20, v99
  v_mfma_f32_32x32x16_bf16 v[112:127], v[208:211], v[32:35], 0
  buffer_load_dwordx4 v241, s[8:11], s28 offen lds
  v_mfma_f32_32x32x16_bf16 v[80:95], v[220:223], v[24:27], v[80:95]
  v_exp_f32 v98, v98
  v_exp_f32 v99, v99
  v_mul_f32 v100, s20, v100
  v_mul_f32 v101, s20, v101
  v_mfma_f32_32x32x16_bf16 v[112:127], v[212:215], v[40:43], v[112:127]
  v_mul_f32 v102, s20, v102
  v_mul_f32 v103, s20, v103
  ds_read_b128 v[228:231], v239 offset:16
  v_exp_f32 v100, v100
  v_exp_f32 v101, v101
  s_waitcnt lgkmcnt(2)
  v_mfma_f32_32x32x16_bf16 v[80:95], v[224:227], v[64:67], v[80:95]
  v_exp_f32 v102, v102
  v_exp_f32 v103, v103
  v_add_f32 v96, 1.0, v96
  v_add_f32 v97, 1.0, v97
  v_mfma_f32_32x32x16_bf16 v[112:127], v[216:219], v[48:51], v[112:127]
  v_rcp_f32 v96, v96
  v_rcp_f32 v97, v97
  v_add_f32 v98, 1.0, v98
  v_add_f32 v99, 1.0, v99
  v_mfma_f32_32x32x16_bf16 v[112:127], v[220:223], v[56:59], v[112:127]
  v_mul_f32 v104, s20, v104
  v_mul_f32 v105, s20, v105
  v_rcp_f32 v98, v98
  v_rcp_f32 v99, v99
  s_waitcnt lgkmcnt(0)
  v_mfma_f32_32x32x16_bf16 v[80:95], v[228:231], v[72:75], v[80:95]
  v_add_f32 v100, 1.0, v100
  v_add_f32 v101, 1.0, v101
  v_add_f32 v102, 1.0, v102
  v_add_f32 v103, 1.0, v103
  v_exp_f32 v104, v104
  v_exp_f32 v105, v105
  v_mul_f32 v106, s20, v106
  v_mul_f32 v107, s20, v107
  v_rcp_f32 v100, v100
  v_rcp_f32 v101, v101
  v_rcp_f32 v102, v102
  v_rcp_f32 v103, v103
  v_mul_f32 v128, v96, v128
  v_mul_f32 v129, v97, v129
  v_exp_f32 v106, v106
  v_exp_f32 v107, v107
  v_mul_f32 v108, s20, v108
  v_mul_f32 v109, s20, v109
  v_mul_f32 v110, s20, v110
  v_mul_f32 v111, s20, v111
  v_lshl_add_u32 v242, v242, 7, v232
  s_add_u32 m0, s27, 6336
  v_mul_f32 v130, v98, v130
  v_mul_f32 v131, v99, v131
  v_exp_f32 v108, v108
  v_exp_f32 v109, v109
  v_exp_f32 v110, v110
  v_exp_f32 v111, v111
  v_cvt_pk_bf16_f32 v96, v96, v97
  v_cvt_pk_bf16_f32 v128, v128, v129
  buffer_load_dwordx4 v242, s[8:11], s28 offen lds
  v_add_f32 v104, 1.0, v104
  v_add_f32 v105, 1.0, v105
  v_mul_f32 v132, v100, v132
  v_mul_f32 v133, v101, v133
  v_mul_f32 v134, v102, v134
  v_mul_f32 v135, v103, v135
  v_cvt_pk_bf16_f32 v97, v98, v99
  v_cvt_pk_bf16_f32 v129, v130, v131
  v_rcp_f32 v104, v104
  v_rcp_f32 v105, v105
  v_add_f32 v106, 1.0, v106
  v_add_f32 v107, 1.0, v107
  v_cvt_pk_bf16_f32 v98, v100, v101
  v_cvt_pk_bf16_f32 v99, v102, v103
  v_cvt_pk_bf16_f32 v130, v132, v133
  v_cvt_pk_bf16_f32 v131, v134, v135
  v_mfma_f32_32x32x16_bf16 v[160:175], v[248:251], v[96:99], v[160:175]
  v_rcp_f32 v106, v106
  v_rcp_f32 v107, v107
  v_add_f32 v108, 1.0, v108
  v_add_f32 v109, 1.0, v109
  v_mfma_f32_32x32x16_bf16 v[192:207], v[248:251], v[128:131], v[192:207]
  v_add_f32 v110, 1.0, v110
  v_add_f32 v111, 1.0, v111
  v_rcp_f32 v108, v108
  v_rcp_f32 v109, v109
  v_rcp_f32 v110, v110
  v_rcp_f32 v111, v111
  v_mul_f32 v136, v104, v136
  v_mul_f32 v137, v105, v137
  v_mul_f32 v138, v106, v138
  v_mul_f32 v139, v107, v139
  v_cvt_pk_bf16_f32 v104, v104, v105
  v_cvt_pk_bf16_f32 v136, v136, v137
  v_mul_f32 v140, v108, v140
  v_mul_f32 v141, v109, v141
  v_mul_f32 v142, v110, v142
  v_mul_f32 v143, v111, v143
  v_cvt_pk_bf16_f32 v105, v106, v107
  v_cvt_pk_bf16_f32 v137, v138, v139
  v_lshl_add_u32 v243, v243, 7, v232
  s_add_u32 m0, s27, 7392
  v_cvt_pk_bf16_f32 v106, v108, v109
  v_cvt_pk_bf16_f32 v107, v110, v111
  v_cvt_pk_bf16_f32 v138, v140, v141
  v_cvt_pk_bf16_f32 v139, v142, v143
  v_mfma_f32_32x32x16_bf16 v[160:175], v[252:255], v[104:107], v[160:175]
  buffer_load_dwordx4 v243, s[8:11], s28 offen lds
  v_mfma_f32_32x32x16_bf16 v[192:207], v[252:255], v[136:139], v[192:207]
  s_add_u32 s26, s26, 1
  s_cmp_gt_u32 s26, s93
  s_cbranch_scc1 K3_PA0
  s_setprio 1
  s_branch K3_PB0
K3_PA0:
  s_setprio 0
K3_PB0:
  s_cmp_ge_u32 s26, s25
  s_cbranch_scc1 K3_NEXT
  v_mfma_f32_32x32x16_bf16 v[96:111], v[208:211], v[4:7], 0
  v_mov_b32 v246, s95
  ds_read_b32 v246, v246
  v_mov_b32 v244, s94
  v_mov_b32 v245, s26
  ds_write_b32 v244, v245
  v_med3_i32 v244, v236, 32, 60
  v_mfma_f32_32x32x16_bf16 v[128:143], v[208:211], v[36:39], 0
  v_med3_i32 v245, v237, 32, 60
  v_lshlrev_b32_e64 v245, v245, 8
  v_lshlrev_b32_e64 v244, v244, 8
  v_mul_f32 v80, s20, v80
  v_exp_f32 v80, v80
  v_mfma_f32_32x32x16_bf16 v[96:111], v[212:215], v[12:15], v[96:111]
  v_mul_f32 v81, s20, v81
  v_exp_f32 v81, v81
  v_mul_f32 v82, s20, v82
  v_mul_f32 v83, s20, v83
  v_exp_f32 v82, v82
  v_mfma_f32_32x32x16_bf16 v[128:143], v[212:215], v[44:47], v[128:143]
  v_exp_f32 v83, v83
  v_mul_f32 v84, s20, v84
  v_mul_f32 v85, s20, v85
  s_waitcnt lgkmcnt(1)
  v_readfirstlane_b32 s93, v246
  v_sub_u32 v246, v245, v244
  v_mfma_f32_32x32x16_bf16 v[96:111], v[216:219], v[20:23], v[96:111]
  v_and_b32 v244, 0x78, v246
  v_and_b32_sdwa v245, s24, v246 dst_sel:DWORD dst_unused:UNUSED_PAD src0_sel:DWORD src1_sel:BYTE_1
  ds_read_b64 v[248:249], v244 offset:2048
  ds_read_b64 v[250:251], v245 offset:2048
  v_and_b32_sdwa v247, s24, v246 dst_sel:DWORD dst_unused:UNUSED_PAD src0_sel:DWORD src1_sel:BYTE_2
  v_and_b32_sdwa v246, s24, v246 dst_sel:DWORD dst_unused:UNUSED_PAD src0_sel:DWORD src1_sel:BYTE_3
  v_mfma_f32_32x32x16_bf16 v[128:143], v[216:219], v[52:55], v[128:143]
  ds_read_b64 v[252:253], v247 offset:2048
  ds_read_b64 v[254:255], v246 offset:2048
  v_mul_f32 v86, s20, v86
  v_mul_f32 v87, s20, v87
  v_add_f32 v80, 1.0, v80
  v_exp_f32 v84, v84
  v_mfma_f32_32x32x16_bf16 v[96:111], v[220:223], v[28:31], v[96:111]
  v_exp_f32 v85, v85
  v_exp_f32 v86, v86
  v_exp_f32 v87, v87
  v_mfma_f32_32x32x16_bf16 v[128:143], v[220:223], v[60:63], v[128:143]
  v_rcp_f32 v80, v80
  v_add_f32 v81, 1.0, v81
  s_waitcnt vmcnt(4)
  ds_read_b128 v[208:211], v233 offset:0
  v_mul_f32 v88, s20, v88
  v_rcp_f32 v81, v81
  v_mfma_f32_32x32x16_bf16 v[96:111], v[224:227], v[68:71], v[96:111]
  v_add_f32 v82, 1.0, v82
  v_add_f32 v83, 1.0, v83
  ds_read_u16 v240, v234 offset:2048
  v_exp_f32 v88, v88
  v_mul_f32 v89, s20, v89
  v_mfma_f32_32x32x16_bf16 v[96:111], v[228:231], v[76:79], v[96:111]
  v_rcp_f32 v82, v82
  v_rcp_f32 v83, v83
  v_add_f32 v84, 1.0, v84
  v_add_f32 v85, 1.0, v85
  v_add_f32 v86, 1.0, v86
  v_add_f32 v87, 1.0, v87
  ds_read_b128 v[212:215], v233 offset:32
  ds_read_b128 v[216:219], v233 offset:64
  ds_read_b128 v[220:223], v233 offset:96
  v_mul_f32 v112, v80, v112
  v_exp_f32 v89, v89
  v_mul_f32 v90, s20, v90
  v_mul_f32 v91, s20, v91
  v_rcp_f32 v84, v84
  v_rcp_f32 v85, v85
  v_rcp_f32 v86, v86
  v_rcp_f32 v87, v87
  v_mul_f32 v113, v81, v113
  v_exp_f32 v90, v90
  v_exp_f32 v91, v91
  v_mul_f32 v92, s20, v92
  v_mul_f32 v93, s20, v93
  v_mul_f32 v94, s20, v94
  v_mul_f32 v95, s20, v95
  v_cvt_pk_bf16_f32 v80, v80, v81
  v_add_f32 v88, 1.0, v88
  v_mul_f32 v114, v82, v114
  v_mul_f32 v115, v83, v115
  v_exp_f32 v92, v92
  v_exp_f32 v93, v93
  v_exp_f32 v94, v94
  v_exp_f32 v95, v95
  v_cvt_pk_bf16_f32 v81, v82, v83
  v_rcp_f32 v88, v88
  v_add_f32 v89, 1.0, v89
  ds_read_b64 v[224:225], v235 offset:1024
  v_cvt_pk_bf16_f32 v82, v84, v85
  v_cvt_pk_bf16_f32 v83, v86, v87
  v_rcp_f32 v89, v89
  s_waitcnt lgkmcnt(8)
s_nop 0
  v_mfma_f32_32x32x16_bf16 v[144:159], v[248:251], v[80:83], v[144:159]
  v_add_f32 v90, 1.0, v90
  v_add_f32 v91, 1.0, v91
  v_rcp_f32 v90, v90
  v_rcp_f32 v91, v91
  v_add_f32 v92, 1.0, v92
  v_add_f32 v93, 1.0, v93
  v_add_f32 v94, 1.0, v94
  v_add_f32 v95, 1.0, v95
  v_mul_f32 v120, v88, v120
  v_rcp_f32 v92, v92
  v_rcp_f32 v93, v93
  v_rcp_f32 v94, v94
  v_rcp_f32 v95, v95
  ds_read_u16 v241, v234 offset:2176
  v_mul_f32 v121, v89, v121
  v_cvt_pk_bf16_f32 v88, v88, v89
  v_mul_f32 v122, v90, v122
  v_mul_f32 v123, v91, v123
  v_cvt_pk_bf16_f32 v89, v90, v91
  v_cvt_pk_bf16_f32 v90, v92, v93
  v_cvt_pk_bf16_f32 v91, v94, v95
  s_add_u32 s29, s26, 3
  v_mul_f32 v116, v84, v116
  s_waitcnt lgkmcnt(7)
  v_mfma_f32_32x32x16_bf16 v[144:159], v[252:255], v[88:91], v[144:159]
  v_mul_f32 v117, v85, v117
  v_mul_f32 v118, v86, v118
  v_mul_f32 v119, v87, v119
  v_mul_f32 v124, v92, v124
  v_mul_f32 v125, v93, v125
  v_mul_f32 v126, v94, v126
  v_mul_f32 v127, v95, v127
  s_waitcnt lgkmcnt(6)
  v_mfma_f32_32x32x16_bf16 v[80:95], v[208:211], v[0:3], 0
  v_cvt_pk_bf16_f32 v112, v112, v113
  s_cmp_lt_u32 s29, s25
  v_cvt_pk_bf16_f32 v113, v114, v115
  s_cselect_b32 s28, 0, 0x80000000
  ds_read_u16 v242, v234 offset:2304
  v_cvt_pk_bf16_f32 v114, v116, v117
  s_waitcnt lgkmcnt(5)
  v_mfma_f32_32x32x16_bf16 v[80:95], v[212:215], v[8:11], v[80:95]
  v_cvt_pk_bf16_f32 v115, v118, v119
  v_lshl_add_u32 v240, v240, 7, v232
  s_add_u32 m0, s27, 0
  s_waitcnt lgkmcnt(3)
s_nop 0
  buffer_load_dwordx4 v240, s[8:11], s28 offen lds
  v_mfma_f32_32x32x16_bf16 v[176:191], v[248:251], v[112:115], v[176:191]
  v_cvt_pk_bf16_f32 v120, v120, v121
  s_waitcnt lgkmcnt(2)
  v_and_or_b32 v239, v225, s21, v238
  v_cvt_pk_bf16_f32 v121, v122, v123
  ds_read_b32 v225, v239 offset:4
  ds_read_b64 v[226:227], v239 offset:8
  v_cvt_pk_bf16_f32 v122, v124, v125
  v_mfma_f32_32x32x16_bf16 v[80:95], v[216:219], v[16:19], v[80:95]
  v_cvt_pk_bf16_f32 v123, v126, v127
  ds_read_u16 v243, v234 offset:2432
  v_mul_f32 v96, s20, v96
  v_mul_f32 v97, s20, v97
  s_waitcnt lgkmcnt(4)
  v_lshl_add_u32 v241, v241, 7, v232
  s_add_u32 m0, s27, 1056
  v_mfma_f32_32x32x16_bf16 v[176:191], v[252:255], v[120:123], v[176:191]
  v_exp_f32 v96, v96
  v_exp_f32 v97, v97
  v_mul_f32 v98, s20, v98
  v_mul_f32 v99, s20, v99
  v_mfma_f32_32x32x16_bf16 v[112:127], v[208:211], v[32:35], 0
  buffer_load_dwordx4 v241, s[8:11], s28 offen lds
  v_mfma_f32_32x32x16_bf16 v[80:95], v[220:223], v[24:27], v[80:95]
  v_exp_f32 v98, v98
  v_exp_f32 v99, v99
  v_mul_f32 v100, s20, v100
  v_mul_f32 v101, s20, v101
  v_mfma_f32_32x32x16_bf16 v[112:127], v[212:215], v[40:43], v[112:127]
  v_mul_f32 v102, s20, v102
  v_mul_f32 v103, s20, v103
  ds_read_b128 v[228:231], v239 offset:16
  v_exp_f32 v100, v100
  v_exp_f32 v101, v101
  s_waitcnt lgkmcnt(2)
  v_mfma_f32_32x32x16_bf16 v[80:95], v[224:227], v[64:67], v[80:95]
  v_exp_f32 v102, v102
  v_exp_f32 v103, v103
  v_add_f32 v96, 1.0, v96
  v_add_f32 v97, 1.0, v97
  v_mfma_f32_32x32x16_bf16 v[112:127], v[216:219], v[48:51], v[112:127]
  v_rcp_f32 v96, v96
  v_rcp_f32 v97, v97
  v_add_f32 v98, 1.0, v98
  v_add_f32 v99, 1.0, v99
  v_mfma_f32_32x32x16_bf16 v[112:127], v[220:223], v[56:59], v[112:127]
  v_mul_f32 v104, s20, v104
  v_mul_f32 v105, s20, v105
  v_rcp_f32 v98, v98
  v_rcp_f32 v99, v99
  s_waitcnt lgkmcnt(0)
  v_mfma_f32_32x32x16_bf16 v[80:95], v[228:231], v[72:75], v[80:95]
  v_add_f32 v100, 1.0, v100
  v_add_f32 v101, 1.0, v101
  v_add_f32 v102, 1.0, v102
  v_add_f32 v103, 1.0, v103
  v_exp_f32 v104, v104
  v_exp_f32 v105, v105
  v_mul_f32 v106, s20, v106
  v_mul_f32 v107, s20, v107
  v_rcp_f32 v100, v100
  v_rcp_f32 v101, v101
  v_rcp_f32 v102, v102
  v_rcp_f32 v103, v103
  v_mul_f32 v128, v96, v128
  v_mul_f32 v129, v97, v129
  v_exp_f32 v106, v106
  v_exp_f32 v107, v107
  v_mul_f32 v108, s20, v108
  v_mul_f32 v109, s20, v109
  v_mul_f32 v110, s20, v110
  v_mul_f32 v111, s20, v111
  v_lshl_add_u32 v242, v242, 7, v232
  s_add_u32 m0, s27, 2112
  v_mul_f32 v130, v98, v130
  v_mul_f32 v131, v99, v131
  v_exp_f32 v108, v108
  v_exp_f32 v109, v109
  v_exp_f32 v110, v110
  v_exp_f32 v111, v111
  v_cvt_pk_bf16_f32 v96, v96, v97
  v_cvt_pk_bf16_f32 v128, v128, v129
  buffer_load_dwordx4 v242, s[8:11], s28 offen lds
  v_add_f32 v104, 1.0, v104
  v_add_f32 v105, 1.0, v105
  v_mul_f32 v132, v100, v132
  v_mul_f32 v133, v101, v133
  v_mul_f32 v134, v102, v134
  v_mul_f32 v135, v103, v135
  v_cvt_pk_bf16_f32 v97, v98, v99
  v_cvt_pk_bf16_f32 v129, v130, v131
  v_rcp_f32 v104, v104
  v_rcp_f32 v105, v105
  v_add_f32 v106, 1.0, v106
  v_add_f32 v107, 1.0, v107
  v_cvt_pk_bf16_f32 v98, v100, v101
  v_cvt_pk_bf16_f32 v99, v102, v103
  v_cvt_pk_bf16_f32 v130, v132, v133
  v_cvt_pk_bf16_f32 v131, v134, v135
  v_mfma_f32_32x32x16_bf16 v[160:175], v[248:251], v[96:99], v[160:175]
  v_rcp_f32 v106, v106
  v_rcp_f32 v107, v107
  v_add_f32 v108, 1.0, v108
  v_add_f32 v109, 1.0, v109
  v_mfma_f32_32x32x16_bf16 v[192:207], v[248:251], v[128:131], v[192:207]
  v_add_f32 v110, 1.0, v110
  v_add_f32 v111, 1.0, v111
  v_rcp_f32 v108, v108
  v_rcp_f32 v109, v109
  v_rcp_f32 v110, v110
  v_rcp_f32 v111, v111
  v_mul_f32 v136, v104, v136
  v_mul_f32 v137, v105, v137
  v_mul_f32 v138, v106, v138
  v_mul_f32 v139, v107, v139
  v_cvt_pk_bf16_f32 v104, v104, v105
  v_cvt_pk_bf16_f32 v136, v136, v137
  v_mul_f32 v140, v108, v140
  v_mul_f32 v141, v109, v141
  v_mul_f32 v142, v110, v142
  v_mul_f32 v143, v111, v143
  v_cvt_pk_bf16_f32 v105, v106, v107
  v_cvt_pk_bf16_f32 v137, v138, v139
  v_lshl_add_u32 v243, v243, 7, v232
  s_add_u32 m0, s27, 3168
  v_cvt_pk_bf16_f32 v106, v108, v109
  v_cvt_pk_bf16_f32 v107, v110, v111
  v_cvt_pk_bf16_f32 v138, v140, v141
  v_cvt_pk_bf16_f32 v139, v142, v143
  v_mfma_f32_32x32x16_bf16 v[160:175], v[252:255], v[104:107], v[160:175]
  buffer_load_dwordx4 v243, s[8:11], s28 offen lds
  v_mfma_f32_32x32x16_bf16 v[192:207], v[252:255], v[136:139], v[192:207]
  v_add_u32 v234, 1024, v234
  v_add_u32 v235, 1024, v235
  v_subrev_u32 v236, 64, v236
  v_subrev_u32 v237, 64, v237
  s_add_u32 s26, s26, 1
  s_cmp_gt_u32 s26, s93
  s_cbranch_scc1 K3_PA1
  s_setprio 1
  s_branch K3_PB1
K3_PA1:
  s_setprio 0
K3_PB1:
  s_cmp_lt_u32 s26, s25
  s_cbranch_scc1 K3_LOOP
K3_NEXT:
  s_add_u32 s38, s38, 3584
  s_cmp_lt_u32 s38, s31
  s_cbranch_scc1 K3_BATCH
  v_mbcnt_lo_u32_b32 v80, -1, 0
  v_mbcnt_hi_u32_b32 v80, -1, v80
  v_mov_b32 v95, s3
  v_lshl_add_u32 v95, v95, 6, v80
  v_and_b32 v81, 31, v80
  v_lshrrev_b32 v82, 5, v80
  v_subrev_u32 v85, 4, v81
  v_subrev_u32 v86, 2, v81
  v_cmp_gt_u32 vcc, 4, v81
s_nop 1
  v_cndmask_b32 v85, v85, v86, vcc
  s_mul_i32 s32, s2, 200
  s_add_u32 s32, s32, s34
  v_add_u32 v254, s32, v85
  v_lshlrev_b32 v254, 7, v254
  v_lshl_add_u32 v254, v82, 4, v254
  v_lshrrev_b32 v86, v81, s36
  v_and_b32 v86, 1, v86
  v_cmp_eq_u32 vcc, 1, v86
  v_mov_b32 v87, 0x80000000
s_nop 0
  v_cndmask_b32 v254, v87, v254, vcc
  v_lshlrev_b32 v255, 4, v80
  buffer_load_dwordx4 v[208:211], v254, s[8:11], 0 offen offset:0
  buffer_load_dwordx4 v[212:215], v254, s[8:11], 0 offen offset:32
  buffer_load_dwordx4 v[216:219], v254, s[8:11], 0 offen offset:64
  buffer_load_dwordx4 v[220:223], v254, s[8:11], 0 offen offset:96
  s_mov_b32 s37, 13080576
  buffer_load_dwordx4 v[0:3], v255, s[12:15], s37 offen offset:0
  s_mov_b32 s37, 13080576
  buffer_load_dwordx4 v[4:7], v255, s[12:15], s37 offen offset:1024
  s_mov_b32 s37, 13080576
  buffer_load_dwordx4 v[8:11], v255, s[12:15], s37 offen offset:2048
  s_mov_b32 s37, 13080576
  buffer_load_dwordx4 v[12:15], v255, s[12:15], s37 offen offset:3072
  s_mov_b32 s37, 13084672
  buffer_load_dwordx4 v[16:19], v255, s[12:15], s37 offen offset:0
  s_mov_b32 s37, 13084672
  buffer_load_dwordx4 v[20:23], v255, s[12:15], s37 offen offset:1024
  s_mov_b32 s37, 13084672
  buffer_load_dwordx4 v[24:27], v255, s[12:15], s37 offen offset:2048
  s_mov_b32 s37, 13084672
  buffer_load_dwordx4 v[28:31], v255, s[12:15], s37 offen offset:3072
  s_mul_i32 s32, s2, 200
  s_add_u32 s32, s32, s34
  s_lshl_b32 s32, s32, 7
  v_mbcnt_lo_u32_b32 v112, -1, 0
  v_mbcnt_hi_u32_b32 v112, -1, v112
  v_and_b32 v113, 31, v112
  v_lshrrev_b32 v112, 5, v112
  v_lshl_add_u32 v252, v113, 2, s32
  v_lshl_add_u32 v253, v112, 8, v252
  v_lshl_add_u32 v252, v112, 9, v252
  buffer_load_dword v34, v253, s[8:11], 0 offen offset:0
  buffer_load_dword v35, v253, s[8:11], 0 offen offset:128
  buffer_load_dword v36, v252, s[8:11], 0 offen offset:512
  buffer_load_dword v37, v252, s[8:11], 0 offen offset:640
  buffer_load_dword v38, v252, s[8:11], 0 offen offset:768
  buffer_load_dword v39, v252, s[8:11], 0 offen offset:896
  buffer_load_dword v40, v252, s[8:11], 0 offen offset:1536
  buffer_load_dword v41, v252, s[8:11], 0 offen offset:1664
  buffer_load_dword v42, v252, s[8:11], 0 offen offset:1792
  buffer_load_dword v43, v252, s[8:11], 0 offen offset:1920
  buffer_load_dword v44, v252, s[8:11], 0 offen offset:2560
  buffer_load_dword v45, v252, s[8:11], 0 offen offset:2688
  buffer_load_dword v46, v252, s[8:11], 0 offen offset:2816
  buffer_load_dword v47, v252, s[8:11], 0 offen offset:2944
  s_waitcnt vmcnt(21)
  v_mfma_f32_32x32x16_bf16 v[80:95], v[208:211], v[0:3], 0
  s_waitcnt vmcnt(19)
  v_mfma_f32_32x32x16_bf16 v[80:95], v[212:215], v[8:11], v[80:95]
  s_waitcnt vmcnt(17)
  v_mfma_f32_32x32x16_bf16 v[80:95], v[216:219], v[16:19], v[80:95]
  s_waitcnt vmcnt(15)
  v_mfma_f32_32x32x16_bf16 v[80:95], v[220:223], v[24:27], v[80:95]
  v_mfma_f32_32x32x16_bf16 v[96:111], v[208:211], v[4:7], 0
  v_mfma_f32_32x32x16_bf16 v[96:111], v[212:215], v[12:15], v[96:111]
  v_mfma_f32_32x32x16_bf16 v[96:111], v[216:219], v[20:23], v[96:111]
  s_waitcnt vmcnt(14)
  v_mfma_f32_32x32x16_bf16 v[96:111], v[220:223], v[28:31], v[96:111]
  v_add_f32 v146, s22, v146
  v_rcp_f32 v146, v146
s_nop 5
  v_fma_f32 v82, v178, v146, v82
  v_max_f32 v82, 0, v82
  v_add_f32 v162, s22, v162
  v_rcp_f32 v162, v162
s_nop 0
  v_fma_f32 v98, v194, v162, v98
  v_max_f32 v98, 0, v98
  s_waitcnt vmcnt(13)
  v_lshlrev_b32 v114, 16, v34
  v_and_b32 v130, s23, v34
  v_add_f32 v82, v82, v114
  v_add_f32 v98, v98, v130
  v_cvt_pk_bf16_f32 v114, v82, v98
  v_add_f32 v147, s22, v147
  v_rcp_f32 v147, v147
s_nop 0
  v_fma_f32 v83, v179, v147, v83
  v_max_f32 v83, 0, v83
  v_add_f32 v163, s22, v163
  v_rcp_f32 v163, v163
s_nop 0
  v_fma_f32 v99, v195, v163, v99
  v_max_f32 v99, 0, v99
  s_waitcnt vmcnt(12)
  v_lshlrev_b32 v115, 16, v35
  v_and_b32 v131, s23, v35
  v_add_f32 v83, v83, v115
  v_add_f32 v99, v99, v131
  v_cvt_pk_bf16_f32 v115, v83, v99
  v_add_f32 v148, s22, v148
  v_rcp_f32 v148, v148
s_nop 0
  v_fma_f32 v84, v180, v148, v84
  v_max_f32 v84, 0, v84
  v_add_f32 v164, s22, v164
  v_rcp_f32 v164, v164
s_nop 0
  v_fma_f32 v100, v196, v164, v100
  v_max_f32 v100, 0, v100
  s_waitcnt vmcnt(11)
  v_lshlrev_b32 v116, 16, v36
  v_and_b32 v132, s23, v36
  v_add_f32 v84, v84, v116
  v_add_f32 v100, v100, v132
  v_cvt_pk_bf16_f32 v116, v84, v100
  v_add_f32 v149, s22, v149
  v_rcp_f32 v149, v149
s_nop 0
  v_fma_f32 v85, v181, v149, v85
  v_max_f32 v85, 0, v85
  v_add_f32 v165, s22, v165
  v_rcp_f32 v165, v165
s_nop 0
  v_fma_f32 v101, v197, v165, v101
  v_max_f32 v101, 0, v101
  s_waitcnt vmcnt(10)
  v_lshlrev_b32 v117, 16, v37
  v_and_b32 v133, s23, v37
  v_add_f32 v85, v85, v117
  v_add_f32 v101, v101, v133
  v_cvt_pk_bf16_f32 v117, v85, v101
  v_add_f32 v150, s22, v150
  v_rcp_f32 v150, v150
s_nop 0
  v_fma_f32 v86, v182, v150, v86
  v_max_f32 v86, 0, v86
  v_add_f32 v166, s22, v166
  v_rcp_f32 v166, v166
s_nop 0
  v_fma_f32 v102, v198, v166, v102
  v_max_f32 v102, 0, v102
  s_waitcnt vmcnt(9)
  v_lshlrev_b32 v118, 16, v38
  v_and_b32 v134, s23, v38
  v_add_f32 v86, v86, v118
  v_add_f32 v102, v102, v134
  v_cvt_pk_bf16_f32 v118, v86, v102
  v_add_f32 v151, s22, v151
  v_rcp_f32 v151, v151
s_nop 0
  v_fma_f32 v87, v183, v151, v87
  v_max_f32 v87, 0, v87
  v_add_f32 v167, s22, v167
  v_rcp_f32 v167, v167
s_nop 0
  v_fma_f32 v103, v199, v167, v103
  v_max_f32 v103, 0, v103
  s_waitcnt vmcnt(8)
  v_lshlrev_b32 v119, 16, v39
  v_and_b32 v135, s23, v39
  v_add_f32 v87, v87, v119
  v_add_f32 v103, v103, v135
  v_cvt_pk_bf16_f32 v119, v87, v103
  v_add_f32 v152, s22, v152
  v_rcp_f32 v152, v152
s_nop 0
  v_fma_f32 v88, v184, v152, v88
  v_max_f32 v88, 0, v88
  v_add_f32 v168, s22, v168
  v_rcp_f32 v168, v168
s_nop 0
  v_fma_f32 v104, v200, v168, v104
  v_max_f32 v104, 0, v104
  s_waitcnt vmcnt(7)
  v_lshlrev_b32 v120, 16, v40
  v_and_b32 v136, s23, v40
  v_add_f32 v88, v88, v120
  v_add_f32 v104, v104, v136
  v_cvt_pk_bf16_f32 v120, v88, v104
  v_add_f32 v153, s22, v153
  v_rcp_f32 v153, v153
s_nop 0
  v_fma_f32 v89, v185, v153, v89
  v_max_f32 v89, 0, v89
  v_add_f32 v169, s22, v169
  v_rcp_f32 v169, v169
s_nop 0
  v_fma_f32 v105, v201, v169, v105
  v_max_f32 v105, 0, v105
  s_waitcnt vmcnt(6)
  v_lshlrev_b32 v121, 16, v41
  v_and_b32 v137, s23, v41
  v_add_f32 v89, v89, v121
  v_add_f32 v105, v105, v137
  v_cvt_pk_bf16_f32 v121, v89, v105
  v_add_f32 v154, s22, v154
  v_rcp_f32 v154, v154
s_nop 0
  v_fma_f32 v90, v186, v154, v90
  v_max_f32 v90, 0, v90
  v_add_f32 v170, s22, v170
  v_rcp_f32 v170, v170
s_nop 0
  v_fma_f32 v106, v202, v170, v106
  v_max_f32 v106, 0, v106
  s_waitcnt vmcnt(5)
  v_lshlrev_b32 v122, 16, v42
  v_and_b32 v138, s23, v42
  v_add_f32 v90, v90, v122
  v_add_f32 v106, v106, v138
  v_cvt_pk_bf16_f32 v122, v90, v106
  v_add_f32 v155, s22, v155
  v_rcp_f32 v155, v155
s_nop 0
  v_fma_f32 v91, v187, v155, v91
  v_max_f32 v91, 0, v91
  v_add_f32 v171, s22, v171
  v_rcp_f32 v171, v171
s_nop 0
  v_fma_f32 v107, v203, v171, v107
  v_max_f32 v107, 0, v107
  s_waitcnt vmcnt(4)
  v_lshlrev_b32 v123, 16, v43
  v_and_b32 v139, s23, v43
  v_add_f32 v91, v91, v123
  v_add_f32 v107, v107, v139
  v_cvt_pk_bf16_f32 v123, v91, v107
  v_add_f32 v156, s22, v156
  v_rcp_f32 v156, v156
s_nop 0
  v_fma_f32 v92, v188, v156, v92
  v_max_f32 v92, 0, v92
  v_add_f32 v172, s22, v172
  v_rcp_f32 v172, v172
s_nop 0
  v_fma_f32 v108, v204, v172, v108
  v_max_f32 v108, 0, v108
  s_waitcnt vmcnt(3)
  v_lshlrev_b32 v124, 16, v44
  v_and_b32 v140, s23, v44
  v_add_f32 v92, v92, v124
  v_add_f32 v108, v108, v140
  v_cvt_pk_bf16_f32 v124, v92, v108
  v_add_f32 v157, s22, v157
  v_rcp_f32 v157, v157
s_nop 0
  v_fma_f32 v93, v189, v157, v93
  v_max_f32 v93, 0, v93
  v_add_f32 v173, s22, v173
  v_rcp_f32 v173, v173
s_nop 0
  v_fma_f32 v109, v205, v173, v109
  v_max_f32 v109, 0, v109
  s_waitcnt vmcnt(2)
  v_lshlrev_b32 v125, 16, v45
  v_and_b32 v141, s23, v45
  v_add_f32 v93, v93, v125
  v_add_f32 v109, v109, v141
  v_cvt_pk_bf16_f32 v125, v93, v109
  v_add_f32 v158, s22, v158
  v_rcp_f32 v158, v158
s_nop 0
  v_fma_f32 v94, v190, v158, v94
  v_max_f32 v94, 0, v94
  v_add_f32 v174, s22, v174
  v_rcp_f32 v174, v174
s_nop 0
  v_fma_f32 v110, v206, v174, v110
  v_max_f32 v110, 0, v110
  s_waitcnt vmcnt(1)
  v_lshlrev_b32 v126, 16, v46
  v_and_b32 v142, s23, v46
  v_add_f32 v94, v94, v126
  v_add_f32 v110, v110, v142
  v_cvt_pk_bf16_f32 v126, v94, v110
  v_add_f32 v159, s22, v159
  v_rcp_f32 v159, v159
s_nop 0
  v_fma_f32 v95, v191, v159, v95
  v_max_f32 v95, 0, v95
  v_add_f32 v175, s22, v175
  v_rcp_f32 v175, v175
s_nop 0
  v_fma_f32 v111, v207, v175, v111
  v_max_f32 v111, 0, v111
  s_waitcnt vmcnt(0)
  v_lshlrev_b32 v127, 16, v47
  v_and_b32 v143, s23, v47
  v_add_f32 v95, v95, v127
  v_add_f32 v111, v111, v143
  v_cvt_pk_bf16_f32 v127, v95, v111
  s_cmp_lt_u32 0, s35
  s_cselect_b32 exec_lo, -1, 0
  s_cmp_lt_u32 2, s35
  s_cselect_b32 exec_hi, -1, 0
  buffer_store_dword v114, v253, s[16:19], 0 offen offset:0 sc0 sc1
  s_cmp_lt_u32 1, s35
  s_cselect_b32 exec_lo, -1, 0
  s_cmp_lt_u32 3, s35
  s_cselect_b32 exec_hi, -1, 0
  buffer_store_dword v115, v253, s[16:19], 0 offen offset:128 sc0 sc1
  s_cmp_lt_u32 4, s35
  s_cselect_b32 exec_lo, -1, 0
  s_cmp_lt_u32 8, s35
  s_cselect_b32 exec_hi, -1, 0
  buffer_store_dword v116, v252, s[16:19], 0 offen offset:512 sc0 sc1
  s_cmp_lt_u32 5, s35
  s_cselect_b32 exec_lo, -1, 0
  s_cmp_lt_u32 9, s35
  s_cselect_b32 exec_hi, -1, 0
  buffer_store_dword v117, v252, s[16:19], 0 offen offset:640 sc0 sc1
  s_cmp_lt_u32 6, s35
  s_cselect_b32 exec_lo, -1, 0
  s_cmp_lt_u32 10, s35
  s_cselect_b32 exec_hi, -1, 0
  buffer_store_dword v118, v252, s[16:19], 0 offen offset:768 sc0 sc1
  s_cmp_lt_u32 7, s35
  s_cselect_b32 exec_lo, -1, 0
  s_cmp_lt_u32 11, s35
  s_cselect_b32 exec_hi, -1, 0
  buffer_store_dword v119, v252, s[16:19], 0 offen offset:896 sc0 sc1
  s_cmp_lt_u32 12, s35
  s_cselect_b32 exec_lo, -1, 0
  s_cmp_lt_u32 16, s35
  s_cselect_b32 exec_hi, -1, 0
  buffer_store_dword v120, v252, s[16:19], 0 offen offset:1536 sc0 sc1
  s_cmp_lt_u32 13, s35
  s_cselect_b32 exec_lo, -1, 0
  s_cmp_lt_u32 17, s35
  s_cselect_b32 exec_hi, -1, 0
  buffer_store_dword v121, v252, s[16:19], 0 offen offset:1664 sc0 sc1
  s_cmp_lt_u32 14, s35
  s_cselect_b32 exec_lo, -1, 0
  s_cmp_lt_u32 18, s35
  s_cselect_b32 exec_hi, -1, 0
  buffer_store_dword v122, v252, s[16:19], 0 offen offset:1792 sc0 sc1
  s_cmp_lt_u32 15, s35
  s_cselect_b32 exec_lo, -1, 0
  s_cmp_lt_u32 19, s35
  s_cselect_b32 exec_hi, -1, 0
  buffer_store_dword v123, v252, s[16:19], 0 offen offset:1920 sc0 sc1
  s_cmp_lt_u32 20, s35
  s_cselect_b32 exec_lo, -1, 0
  s_cmp_lt_u32 24, s35
  s_cselect_b32 exec_hi, -1, 0
  buffer_store_dword v124, v252, s[16:19], 0 offen offset:2560 sc0 sc1
  s_cmp_lt_u32 21, s35
  s_cselect_b32 exec_lo, -1, 0
  s_cmp_lt_u32 25, s35
  s_cselect_b32 exec_hi, -1, 0
  buffer_store_dword v125, v252, s[16:19], 0 offen offset:2688 sc0 sc1
  s_cmp_lt_u32 22, s35
  s_cselect_b32 exec_lo, -1, 0
  s_cmp_lt_u32 26, s35
  s_cselect_b32 exec_hi, -1, 0
  buffer_store_dword v126, v252, s[16:19], 0 offen offset:2816 sc0 sc1
  s_cmp_lt_u32 23, s35
  s_cselect_b32 exec_lo, -1, 0
  s_cmp_lt_u32 27, s35
  s_cselect_b32 exec_hi, -1, 0
  buffer_store_dword v127, v252, s[16:19], 0 offen offset:2944 sc0 sc1
  s_mov_b64 exec, -1
K3_END:
  s_endpgm
.section .rodata,"a"
.p2align 6
.amdhsa_kernel k1_kernel
  .amdhsa_next_free_vgpr 128
  .amdhsa_next_free_sgpr 64
  .amdhsa_accum_offset 128
  .amdhsa_group_segment_fixed_size 0
  .amdhsa_kernarg_size 96
  .amdhsa_user_sgpr_count 2
  .amdhsa_user_sgpr_kernarg_segment_ptr 1
  .amdhsa_system_sgpr_workgroup_id_x 1
.end_amdhsa_kernel
.p2align 6
.amdhsa_kernel k3_kernel
  .amdhsa_next_free_vgpr 256
  .amdhsa_next_free_sgpr 102
  .amdhsa_accum_offset 256
  .amdhsa_group_segment_fixed_size 0
  .amdhsa_kernarg_size 96
  .amdhsa_user_sgpr_count 2
  .amdhsa_user_sgpr_kernarg_segment_ptr 1
  .amdhsa_system_sgpr_workgroup_id_x 1
.end_amdhsa_kernel
```
